```python
import torch

def _softmax(x, axis=-1):
    return torch.softmax(x, dim=axis)
def _gelu(x):
    return torch.nn.functional.gelu(x, approximate="tanh")
def _silu(x):
    return torch.nn.functional.silu(x)
def _sigmoid(x):
    return torch.sigmoid(x)
def _layernorm(x, axis=-1, eps=1e-5):
    m = x.mean(dim=axis, keepdim=True)
    v = x.var(dim=axis, keepdim=True, unbiased=False)
    return (x - m) / torch.sqrt(v + eps)
def _scatter_add(tgt, idx, src, axis=0):
    return tgt.clone().index_add_(axis, idx, src)
def _segment_sum(src, seg, n):
    out = torch.zeros((n,) + src.shape[1:], dtype=src.dtype)
    return out.index_add_(0, seg, src)
def _pad(x, pw):
    flat = tuple(v for pair in reversed(pw) for v in pair)
    return torch.nn.functional.pad(x, flat)

kernel_name = 'sequential_preLN__ssm_conv_h3__glu_gated_geglu__prompt'

def setup_inputs():

    _w = (lambda a: (lambda t: t.to(torch.bfloat16) if t.is_floating_point() else t)(torch.as_tensor(a)))
    def _A_setup():
        B, S, D = 1, 2048, 640
        ks = 4
        return {
            "q": _w((lambda *s: torch.randn(*s, dtype=torch.bfloat16) * 0.05)(B, S, D)),
            "k": _w((lambda *s: torch.randn(*s, dtype=torch.bfloat16) * 0.2)(B, S, D)),
            "v": _w((lambda *s: torch.randn(*s, dtype=torch.bfloat16) * 0.2)(B, S, D)),
            "shift_k": _w((lambda *s: torch.randn(*s, dtype=torch.bfloat16) * 0.2)(D, ks) * 0.5),
            "ssm_k": _w((lambda *s: torch.randn(*s, dtype=torch.bfloat16) * 0.4)(D, S) * (1.0 / S ** 0.5)),
            "ssm_D": _w((lambda *s: torch.randn(*s, dtype=torch.bfloat16) * 0.2)(D)),
        }
    _A_in = _A_setup()

    def _B_setup():
        B, S, Dm, Df = 1, 2048, 640, 1536
        return {
            "x": _w((lambda *s: torch.randn(*s, dtype=torch.bfloat16) * 0.05)(B, S, Dm)),
            "w_gate": _w((lambda *s: torch.randn(*s, dtype=torch.bfloat16) * 0.4)(Dm, Df) * (Dm ** -0.5)),
            "w_up": _w((lambda *s: torch.randn(*s, dtype=torch.bfloat16) * 0.4)(Dm, Df) * (Dm ** -0.5)),
            "w_down": _w((lambda *s: torch.randn(*s, dtype=torch.bfloat16) * 0.4)(Df, Dm) * (Df ** -0.5)),
        }
    _B_in = _B_setup()

    return {
        "A_q": _A_in["q"],
        "A_k": _A_in["k"],
        "A_v": _A_in["v"],
        "A_shift_k": _A_in["shift_k"],
        "A_ssm_k": _A_in["ssm_k"],
        "A_ssm_D": _A_in["ssm_D"],
        "B_x": _B_in["x"],
        "B_w_gate": _B_in["w_gate"],
        "B_w_up": _B_in["w_up"],
        "B_w_down": _B_in["w_down"],
    }

def reference(A_q, A_k, A_v, A_shift_k, A_ssm_k, A_ssm_D, B_x, B_w_gate, B_w_up, B_w_down):
    def _A_ref(q, k, v, shift_k, ssm_k, ssm_D):
        B, S, D = q.shape
        ks = shift_k.shape[-1]
        k_pad = _pad(k, ((0, 0), (ks - 1, 0), (0, 0)))
        k_shift = torch.zeros_like(k)
        for t in range(ks):
            k_shift = k_shift + k_pad[:, t:t + S, :] * shift_k[:, ks - 1 - t][None, None, :]
        kv = k_shift * v
        L = 2 * S
        kv_pad = _pad(kv, ((0, 0), (0, S), (0, 0)))
        kf_pad = _pad(ssm_k, ((0, 0), (0, S)))
        kv_f = (lambda x, axes=(-2,-1): torch.fft.rfft2(x.float(), dim=axes))(kv_pad[:, None, :, :], axes=(1, 2))
        kf_f = (lambda x, axes=(-2,-1): torch.fft.rfft2(x.float(), dim=axes))(kf_pad[:, None, :], axes=(1, 2))
        kf_f = (lambda x, *d: x.permute(*d))(kf_f, 1, 2, 0)
        y_f = kv_f * kf_f[None, :, :, :]
        y = (lambda x, s, axes=(-2,-1): torch.fft.irfft2(x, s=s, dim=axes).to(torch.bfloat16))(y_f, (1, L), axes=(1, 2))[:, 0, :S, :]
        y = y + kv * ssm_D[None, None, :]
        return q * y

    def _B_ref(x, w_gate, w_up, w_down):
        g = torch.einsum("bsd,df->bsf", x, w_gate)
        u = torch.einsum("bsd,df->bsf", x, w_up)
        h = _gelu(g) * u
        return torch.einsum("bsf,fd->bsd", h, w_down)

    x = A_q
    h = x + _A_ref(_layernorm(x, axis=-1), A_k, A_v, A_shift_k, A_ssm_k, A_ssm_D)
    h2 = h + _B_ref(_layernorm(h, axis=-1), B_w_gate, B_w_up, B_w_down)
    return h2
```

```asm
; @launch kernel=prep_kernel grid=(448,1,1) block=(256,1,1) lds=0
; @launch kernel=conv_kernel grid=(736,1,1) block=(256,1,1) lds=42432
; @launch kernel=gemm1_kernel grid=(256,1,1) block=(512,1,1) lds=126976
; @launch kernel=gemm2_kernel grid=(256,1,1) block=(256,1,1) lds=104960
.amdgcn_target "amdgcn-amd-amdhsa--gfx950"
.text
.globl prep_kernel
.p2align 8
.type prep_kernel,@function
prep_kernel:
  s_cmp_ge_u32 s2, 448
  v_readfirstlane_b32 s96, v0
  s_cbranch_scc1 prep_kernel_end
  s_load_dwordx8 s[4:11], s[0:1], 0
  s_load_dwordx2 s[12:13], s[0:1], 32
  s_load_dwordx2 s[16:17], s[0:1], 96
  v_and_b32 v1, 15, v0
  v_lshrrev_b32 v2, 4, v0
  s_waitcnt lgkmcnt(0)
  s_mov_b32 s36, s16
  s_and_b32 s37, s17, 0xffff
  s_mov_b32 s38, 268435456
  s_mov_b32 s39, 0x00020000
  s_mov_b32 s20, s4
  s_and_b32 s21, s5, 0xffff
  s_mov_b32 s22, 2621440
  s_mov_b32 s23, 0x00020000
  s_sub_u32 s3, s2, 160
  s_cmp_lt_u32 s3, 128
  s_cbranch_scc1 prep_b
  s_sub_u32 s3, s2, 288
  s_cmp_ge_u32 s2, 288
  s_cselect_b32 s58, s3, s2
  s_mov_b32 s24, s6
  s_and_b32 s25, s7, 0xffff
  s_mov_b32 s26, 2621440
  s_mov_b32 s27, 0x00020000
  s_mov_b32 s28, s8
  s_and_b32 s29, s9, 0xffff
  s_mov_b32 s30, 2621440
  s_mov_b32 s31, 0x00020000
  s_mov_b32 s32, s10
  s_and_b32 s33, s11, 0xffff
  s_mov_b32 s34, 5120
  s_mov_b32 s35, 0x00020000
  s_mul_i32 s3, s58, 205
  s_lshr_b32 s3, s3, 11
  s_mul_i32 s18, s3, 10
  s_sub_u32 s18, s58, s18
  s_lshl_b32 s3, s3, 7
  v_lshl_add_u32 v3, v2, 3, s3
  s_lshl_b32 s19, s18, 7
  v_lshl_add_u32 v4, v1, 3, s19
  s_movk_i32 s44, 1280
  v_mad_u32_u24 v5, v3, s44, v4
  v_subrev_u32 v6, 3840, v5
  v_bfrev_b32 v7, 1
  v_cmp_eq_u32 vcc, 0, v3
  s_movk_i32 s45, 3840
  s_movk_i32 s46, 7680
  v_cndmask_b32 v6, v6, v7, vcc
  v_lshlrev_b32 v8, 2, v4
  s_movk_i32 s47, 2176
  v_mul_u32_u24 v9, s47, v4
  v_lshl_add_u32 v9, v3, 1, v9
  s_mov_b32 s48, 0
  s_mov_b32 s52, 2818048
  s_mov_b32 s49, 4352
  s_mov_b32 s53, 2822400
  s_mov_b32 s50, 8704
  s_mov_b32 s54, 2826752
  s_mov_b32 s51, 13056
  s_mov_b32 s55, 2831104
  s_mov_b32 s56, 0x05040100
  s_mov_b32 s57, 0x07060302
  s_cmp_ge_u32 s2, 288
  s_cbranch_scc1 prep_q
  buffer_load_dwordx4 v[74:77], v8, s[32:35], 0 offen
  buffer_load_dwordx4 v[78:81], v8, s[32:35], 0 offen offset:16
  buffer_load_dwordx2 v[20:21], v6, s[24:27], 0 offen offset:0
  buffer_load_dwordx2 v[22:23], v6, s[24:27], 0 offen offset:1280
  buffer_load_dwordx2 v[24:25], v6, s[24:27], 0 offen offset:2560
  buffer_load_dwordx2 v[26:27], v5, s[24:27], 0 offen offset:0
  buffer_load_dwordx2 v[28:29], v5, s[24:27], 0 offen offset:1280
  buffer_load_dwordx2 v[30:31], v5, s[24:27], 0 offen offset:2560
  buffer_load_dwordx2 v[32:33], v5, s[24:27], s45 offen offset:0
  buffer_load_dwordx2 v[34:35], v5, s[24:27], s45 offen offset:1280
  buffer_load_dwordx2 v[36:37], v5, s[24:27], s45 offen offset:2560
  buffer_load_dwordx2 v[38:39], v5, s[24:27], s46 offen offset:0
  buffer_load_dwordx2 v[40:41], v5, s[24:27], s46 offen offset:1280
  buffer_load_dwordx2 v[42:43], v5, s[28:31], 0 offen offset:0
  buffer_load_dwordx2 v[44:45], v5, s[28:31], 0 offen offset:1280
  buffer_load_dwordx2 v[46:47], v5, s[28:31], 0 offen offset:2560
  buffer_load_dwordx2 v[48:49], v5, s[28:31], s45 offen offset:0
  buffer_load_dwordx2 v[50:51], v5, s[28:31], s45 offen offset:1280
  buffer_load_dwordx2 v[52:53], v5, s[28:31], s45 offen offset:2560
  buffer_load_dwordx2 v[54:55], v5, s[28:31], s46 offen offset:0
  buffer_load_dwordx2 v[56:57], v5, s[28:31], s46 offen offset:1280
  s_waitcnt vmcnt(19)
  v_lshlrev_b32 v84, 16, v74
  v_and_b32 v88, 0xffff0000, v74
  v_lshlrev_b32 v92, 16, v75
  v_and_b32 v96, 0xffff0000, v75
  v_lshlrev_b32 v85, 16, v76
  v_and_b32 v89, 0xffff0000, v76
  v_lshlrev_b32 v93, 16, v77
  v_and_b32 v97, 0xffff0000, v77
  v_lshlrev_b32 v86, 16, v78
  v_and_b32 v90, 0xffff0000, v78
  v_lshlrev_b32 v94, 16, v79
  v_and_b32 v98, 0xffff0000, v79
  v_lshlrev_b32 v87, 16, v80
  v_and_b32 v91, 0xffff0000, v80
  v_lshlrev_b32 v95, 16, v81
  v_and_b32 v99, 0xffff0000, v81
  s_waitcnt vmcnt(18)
  v_lshlrev_b32 v100, 16, v20
  v_and_b32 v101, 0xffff0000, v20
  v_lshlrev_b32 v102, 16, v21
  v_and_b32 v103, 0xffff0000, v21
  s_waitcnt vmcnt(17)
  v_lshlrev_b32 v104, 16, v22
  v_and_b32 v105, 0xffff0000, v22
  v_lshlrev_b32 v106, 16, v23
  v_and_b32 v107, 0xffff0000, v23
  s_waitcnt vmcnt(16)
  v_lshlrev_b32 v108, 16, v24
  v_and_b32 v109, 0xffff0000, v24
  v_lshlrev_b32 v110, 16, v25
  v_and_b32 v111, 0xffff0000, v25
  s_waitcnt vmcnt(15)
  v_lshlrev_b32 v112, 16, v26
  v_and_b32 v113, 0xffff0000, v26
  v_lshlrev_b32 v114, 16, v27
  v_and_b32 v115, 0xffff0000, v27
  s_waitcnt vmcnt(14)
  v_lshlrev_b32 v116, 16, v28
  v_and_b32 v117, 0xffff0000, v28
  v_lshlrev_b32 v118, 16, v29
  v_and_b32 v119, 0xffff0000, v29
  s_waitcnt vmcnt(13)
  v_lshlrev_b32 v120, 16, v30
  v_and_b32 v121, 0xffff0000, v30
  v_lshlrev_b32 v122, 16, v31
  v_and_b32 v123, 0xffff0000, v31
  s_waitcnt vmcnt(12)
  v_lshlrev_b32 v124, 16, v32
  v_and_b32 v125, 0xffff0000, v32
  v_lshlrev_b32 v126, 16, v33
  v_and_b32 v127, 0xffff0000, v33
  s_waitcnt vmcnt(11)
  v_lshlrev_b32 v128, 16, v34
  v_and_b32 v129, 0xffff0000, v34
  v_lshlrev_b32 v130, 16, v35
  v_and_b32 v131, 0xffff0000, v35
  s_waitcnt vmcnt(10)
  v_lshlrev_b32 v132, 16, v36
  v_and_b32 v133, 0xffff0000, v36
  v_lshlrev_b32 v134, 16, v37
  v_and_b32 v135, 0xffff0000, v37
  s_waitcnt vmcnt(9)
  v_lshlrev_b32 v136, 16, v38
  v_and_b32 v137, 0xffff0000, v38
  v_lshlrev_b32 v138, 16, v39
  v_and_b32 v139, 0xffff0000, v39
  s_waitcnt vmcnt(8)
  v_lshlrev_b32 v140, 16, v40
  v_and_b32 v141, 0xffff0000, v40
  v_lshlrev_b32 v142, 16, v41
  v_and_b32 v143, 0xffff0000, v41
  v_pk_mul_f32 v[144:145], v[100:101], v[96:97]
  v_pk_mul_f32 v[146:147], v[102:103], v[98:99]
  v_pk_fma_f32 v[144:145], v[104:105], v[92:93], v[144:145]
  v_pk_fma_f32 v[146:147], v[106:107], v[94:95], v[146:147]
  v_pk_fma_f32 v[144:145], v[108:109], v[88:89], v[144:145]
  v_pk_fma_f32 v[146:147], v[110:111], v[90:91], v[146:147]
  v_pk_fma_f32 v[144:145], v[112:113], v[84:85], v[144:145]
  v_pk_fma_f32 v[146:147], v[114:115], v[86:87], v[146:147]
  v_pk_mul_f32 v[148:149], v[104:105], v[96:97]
  v_pk_mul_f32 v[150:151], v[106:107], v[98:99]
  v_pk_fma_f32 v[148:149], v[108:109], v[92:93], v[148:149]
  v_pk_fma_f32 v[150:151], v[110:111], v[94:95], v[150:151]
  v_pk_fma_f32 v[148:149], v[112:113], v[88:89], v[148:149]
  v_pk_fma_f32 v[150:151], v[114:115], v[90:91], v[150:151]
  v_pk_fma_f32 v[148:149], v[116:117], v[84:85], v[148:149]
  v_pk_fma_f32 v[150:151], v[118:119], v[86:87], v[150:151]
  v_pk_mul_f32 v[152:153], v[108:109], v[96:97]
  v_pk_mul_f32 v[154:155], v[110:111], v[98:99]
  v_pk_fma_f32 v[152:153], v[112:113], v[92:93], v[152:153]
  v_pk_fma_f32 v[154:155], v[114:115], v[94:95], v[154:155]
  v_pk_fma_f32 v[152:153], v[116:117], v[88:89], v[152:153]
  v_pk_fma_f32 v[154:155], v[118:119], v[90:91], v[154:155]
  v_pk_fma_f32 v[152:153], v[120:121], v[84:85], v[152:153]
  v_pk_fma_f32 v[154:155], v[122:123], v[86:87], v[154:155]
  v_pk_mul_f32 v[156:157], v[112:113], v[96:97]
  v_pk_mul_f32 v[158:159], v[114:115], v[98:99]
  v_pk_fma_f32 v[156:157], v[116:117], v[92:93], v[156:157]
  v_pk_fma_f32 v[158:159], v[118:119], v[94:95], v[158:159]
  v_pk_fma_f32 v[156:157], v[120:121], v[88:89], v[156:157]
  v_pk_fma_f32 v[158:159], v[122:123], v[90:91], v[158:159]
  v_pk_fma_f32 v[156:157], v[124:125], v[84:85], v[156:157]
  v_pk_fma_f32 v[158:159], v[126:127], v[86:87], v[158:159]
  v_pk_mul_f32 v[160:161], v[116:117], v[96:97]
  v_pk_mul_f32 v[162:163], v[118:119], v[98:99]
  v_pk_fma_f32 v[160:161], v[120:121], v[92:93], v[160:161]
  v_pk_fma_f32 v[162:163], v[122:123], v[94:95], v[162:163]
  v_pk_fma_f32 v[160:161], v[124:125], v[88:89], v[160:161]
  v_pk_fma_f32 v[162:163], v[126:127], v[90:91], v[162:163]
  v_pk_fma_f32 v[160:161], v[128:129], v[84:85], v[160:161]
  v_pk_fma_f32 v[162:163], v[130:131], v[86:87], v[162:163]
  v_pk_mul_f32 v[164:165], v[120:121], v[96:97]
  v_pk_mul_f32 v[166:167], v[122:123], v[98:99]
  v_pk_fma_f32 v[164:165], v[124:125], v[92:93], v[164:165]
  v_pk_fma_f32 v[166:167], v[126:127], v[94:95], v[166:167]
  v_pk_fma_f32 v[164:165], v[128:129], v[88:89], v[164:165]
  v_pk_fma_f32 v[166:167], v[130:131], v[90:91], v[166:167]
  v_pk_fma_f32 v[164:165], v[132:133], v[84:85], v[164:165]
  v_pk_fma_f32 v[166:167], v[134:135], v[86:87], v[166:167]
  v_pk_mul_f32 v[168:169], v[124:125], v[96:97]
  v_pk_mul_f32 v[170:171], v[126:127], v[98:99]
  v_pk_fma_f32 v[168:169], v[128:129], v[92:93], v[168:169]
  v_pk_fma_f32 v[170:171], v[130:131], v[94:95], v[170:171]
  v_pk_fma_f32 v[168:169], v[132:133], v[88:89], v[168:169]
  v_pk_fma_f32 v[170:171], v[134:135], v[90:91], v[170:171]
  v_pk_fma_f32 v[168:169], v[136:137], v[84:85], v[168:169]
  v_pk_fma_f32 v[170:171], v[138:139], v[86:87], v[170:171]
  v_pk_mul_f32 v[172:173], v[128:129], v[96:97]
  v_pk_mul_f32 v[174:175], v[130:131], v[98:99]
  v_pk_fma_f32 v[172:173], v[132:133], v[92:93], v[172:173]
  v_pk_fma_f32 v[174:175], v[134:135], v[94:95], v[174:175]
  v_pk_fma_f32 v[172:173], v[136:137], v[88:89], v[172:173]
  v_pk_fma_f32 v[174:175], v[138:139], v[90:91], v[174:175]
  v_pk_fma_f32 v[172:173], v[140:141], v[84:85], v[172:173]
  v_pk_fma_f32 v[174:175], v[142:143], v[86:87], v[174:175]
  s_waitcnt vmcnt(7)
  v_lshlrev_b32 v176, 16, v42
  v_and_b32 v177, 0xffff0000, v42
  v_lshlrev_b32 v178, 16, v43
  v_and_b32 v179, 0xffff0000, v43
  v_pk_mul_f32 v[144:145], v[144:145], v[176:177]
  v_pk_mul_f32 v[146:147], v[146:147], v[178:179]
  s_waitcnt vmcnt(6)
  v_lshlrev_b32 v176, 16, v44
  v_and_b32 v177, 0xffff0000, v44
  v_lshlrev_b32 v178, 16, v45
  v_and_b32 v179, 0xffff0000, v45
  v_pk_mul_f32 v[148:149], v[148:149], v[176:177]
  v_pk_mul_f32 v[150:151], v[150:151], v[178:179]
  s_waitcnt vmcnt(5)
  v_lshlrev_b32 v176, 16, v46
  v_and_b32 v177, 0xffff0000, v46
  v_lshlrev_b32 v178, 16, v47
  v_and_b32 v179, 0xffff0000, v47
  v_pk_mul_f32 v[152:153], v[152:153], v[176:177]
  v_pk_mul_f32 v[154:155], v[154:155], v[178:179]
  s_waitcnt vmcnt(4)
  v_lshlrev_b32 v176, 16, v48
  v_and_b32 v177, 0xffff0000, v48
  v_lshlrev_b32 v178, 16, v49
  v_and_b32 v179, 0xffff0000, v49
  v_pk_mul_f32 v[156:157], v[156:157], v[176:177]
  v_pk_mul_f32 v[158:159], v[158:159], v[178:179]
  s_waitcnt vmcnt(3)
  v_lshlrev_b32 v176, 16, v50
  v_and_b32 v177, 0xffff0000, v50
  v_lshlrev_b32 v178, 16, v51
  v_and_b32 v179, 0xffff0000, v51
  v_pk_mul_f32 v[160:161], v[160:161], v[176:177]
  v_pk_mul_f32 v[162:163], v[162:163], v[178:179]
  s_waitcnt vmcnt(2)
  v_lshlrev_b32 v176, 16, v52
  v_and_b32 v177, 0xffff0000, v52
  v_lshlrev_b32 v178, 16, v53
  v_and_b32 v179, 0xffff0000, v53
  v_pk_mul_f32 v[164:165], v[164:165], v[176:177]
  v_pk_mul_f32 v[166:167], v[166:167], v[178:179]
  s_waitcnt vmcnt(1)
  v_lshlrev_b32 v176, 16, v54
  v_and_b32 v177, 0xffff0000, v54
  v_lshlrev_b32 v178, 16, v55
  v_and_b32 v179, 0xffff0000, v55
  v_pk_mul_f32 v[168:169], v[168:169], v[176:177]
  v_pk_mul_f32 v[170:171], v[170:171], v[178:179]
  s_waitcnt vmcnt(0)
  v_lshlrev_b32 v176, 16, v56
  v_and_b32 v177, 0xffff0000, v56
  v_lshlrev_b32 v178, 16, v57
  v_and_b32 v179, 0xffff0000, v57
  v_pk_mul_f32 v[172:173], v[172:173], v[176:177]
  v_pk_mul_f32 v[174:175], v[174:175], v[178:179]
  v_cvt_pk_bf16_f32 v180, v144, v148
  v_cvt_pk_bf16_f32 v181, v152, v156
  v_cvt_pk_bf16_f32 v182, v160, v164
  v_cvt_pk_bf16_f32 v183, v168, v172
  buffer_store_dwordx4 v[180:183], v9, s[36:39], s48 offen
  v_cvt_pk_bf16_f32 v184, v145, v149
  v_cvt_pk_bf16_f32 v185, v153, v157
  v_cvt_pk_bf16_f32 v186, v161, v165
  v_cvt_pk_bf16_f32 v187, v169, v173
  buffer_store_dwordx4 v[184:187], v9, s[36:39], s49 offen
  v_cvt_pk_bf16_f32 v188, v146, v150
  v_cvt_pk_bf16_f32 v189, v154, v158
  v_cvt_pk_bf16_f32 v190, v162, v166
  v_cvt_pk_bf16_f32 v191, v170, v174
  buffer_store_dwordx4 v[188:191], v9, s[36:39], s50 offen
  v_cvt_pk_bf16_f32 v192, v147, v151
  v_cvt_pk_bf16_f32 v193, v155, v159
  v_cvt_pk_bf16_f32 v194, v163, v167
  v_cvt_pk_bf16_f32 v195, v171, v175
  buffer_store_dwordx4 v[192:195], v9, s[36:39], s51 offen
  s_endpgm
prep_q:
  buffer_load_dwordx2 v[58:59], v5, s[20:23], 0 offen offset:0
  buffer_load_dwordx2 v[60:61], v5, s[20:23], 0 offen offset:1280
  buffer_load_dwordx2 v[62:63], v5, s[20:23], 0 offen offset:2560
  buffer_load_dwordx2 v[64:65], v5, s[20:23], s45 offen offset:0
  buffer_load_dwordx2 v[66:67], v5, s[20:23], s45 offen offset:1280
  buffer_load_dwordx2 v[68:69], v5, s[20:23], s45 offen offset:2560
  buffer_load_dwordx2 v[70:71], v5, s[20:23], s46 offen offset:0
  buffer_load_dwordx2 v[72:73], v5, s[20:23], s46 offen offset:1280
  s_waitcnt vmcnt(0)
  v_perm_b32 v196, v60, v58, s56
  v_perm_b32 v197, v64, v62, s56
  v_perm_b32 v198, v68, v66, s56
  v_perm_b32 v199, v72, v70, s56
  buffer_store_dwordx4 v[196:199], v9, s[36:39], s52 offen
  v_perm_b32 v200, v60, v58, s57
  v_perm_b32 v201, v64, v62, s57
  v_perm_b32 v202, v68, v66, s57
  v_perm_b32 v203, v72, v70, s57
  buffer_store_dwordx4 v[200:203], v9, s[36:39], s53 offen
  v_perm_b32 v204, v61, v59, s56
  v_perm_b32 v205, v65, v63, s56
  v_perm_b32 v206, v69, v67, s56
  v_perm_b32 v207, v73, v71, s56
  buffer_store_dwordx4 v[204:207], v9, s[36:39], s54 offen
  v_perm_b32 v208, v61, v59, s57
  v_perm_b32 v209, v65, v63, s57
  v_perm_b32 v210, v69, v67, s57
  v_perm_b32 v211, v73, v71, s57
  buffer_store_dwordx4 v[208:211], v9, s[36:39], s55 offen
  s_endpgm
prep_b:
  s_mov_b32 s40, s12
  s_and_b32 s41, s13, 0xffff
  s_mov_b32 s42, 2621440
  s_mov_b32 s43, 0x00020000
  s_sub_u32 s3, s2, 160
  s_lshl_b32 s3, s3, 4
  v_add_u32 v3, s3, v2
  s_movk_i32 s44, 1280
  v_lshlrev_b32 v4, 4, v1
  v_mad_u32_u24 v5, v3, s44, v4
  buffer_load_dwordx4 v[20:23], v5, s[20:23], 0 offen offset:0
  buffer_load_dwordx4 v[24:27], v5, s[20:23], 0 offen offset:256
  buffer_load_dwordx4 v[28:31], v5, s[20:23], 0 offen offset:512
  buffer_load_dwordx4 v[32:35], v5, s[20:23], 0 offen offset:768
  buffer_load_dwordx4 v[36:39], v5, s[20:23], 0 offen offset:1024
  buffer_load_dwordx4 v[100:103], v5, s[40:43], 0 offen offset:0
  buffer_load_dwordx4 v[104:107], v5, s[40:43], 0 offen offset:256
  buffer_load_dwordx4 v[108:111], v5, s[40:43], 0 offen offset:512
  buffer_load_dwordx4 v[112:115], v5, s[40:43], 0 offen offset:768
  buffer_load_dwordx4 v[116:119], v5, s[40:43], 0 offen offset:1024
  s_mov_b32 s45, 0x3f803f80
  v_mov_b32 v6, 0
  v_mov_b32 v8, 0
  v_mov_b32 v9, 0
  s_waitcnt vmcnt(9)
  v_dot2_f32_bf16 v6, v20, s45, v6
  v_dot2_f32_bf16 v6, v21, s45, v6
  v_dot2_f32_bf16 v6, v22, s45, v6
  v_dot2_f32_bf16 v6, v23, s45, v6
  s_waitcnt vmcnt(8)
  v_dot2_f32_bf16 v6, v24, s45, v6
  v_dot2_f32_bf16 v6, v25, s45, v6
  v_dot2_f32_bf16 v6, v26, s45, v6
  v_dot2_f32_bf16 v6, v27, s45, v6
  s_waitcnt vmcnt(7)
  v_dot2_f32_bf16 v6, v28, s45, v6
  v_dot2_f32_bf16 v6, v29, s45, v6
  v_dot2_f32_bf16 v6, v30, s45, v6
  v_dot2_f32_bf16 v6, v31, s45, v6
  s_waitcnt vmcnt(6)
  v_dot2_f32_bf16 v6, v32, s45, v6
  v_dot2_f32_bf16 v6, v33, s45, v6
  v_dot2_f32_bf16 v6, v34, s45, v6
  v_dot2_f32_bf16 v6, v35, s45, v6
  s_waitcnt vmcnt(5)
  v_dot2_f32_bf16 v6, v36, s45, v6
  v_dot2_f32_bf16 v6, v37, s45, v6
  v_dot2_f32_bf16 v6, v38, s45, v6
  v_dot2_f32_bf16 v6, v39, s45, v6
  v_lshlrev_b32 v40, 16, v20
  v_and_b32 v41, 0xffff0000, v20
  v_lshlrev_b32 v42, 16, v21
  v_and_b32 v43, 0xffff0000, v21
  v_lshlrev_b32 v44, 16, v22
  v_and_b32 v45, 0xffff0000, v22
  v_lshlrev_b32 v46, 16, v23
  v_and_b32 v47, 0xffff0000, v23
  v_lshlrev_b32 v48, 16, v24
  v_and_b32 v49, 0xffff0000, v24
  v_lshlrev_b32 v50, 16, v25
  v_and_b32 v51, 0xffff0000, v25
  v_lshlrev_b32 v52, 16, v26
  v_and_b32 v53, 0xffff0000, v26
  v_lshlrev_b32 v54, 16, v27
  v_and_b32 v55, 0xffff0000, v27
  v_lshlrev_b32 v56, 16, v28
  v_and_b32 v57, 0xffff0000, v28
  v_lshlrev_b32 v58, 16, v29
  v_and_b32 v59, 0xffff0000, v29
  v_lshlrev_b32 v60, 16, v30
  v_and_b32 v61, 0xffff0000, v30
  v_lshlrev_b32 v62, 16, v31
  v_and_b32 v63, 0xffff0000, v31
  v_lshlrev_b32 v64, 16, v32
  v_and_b32 v65, 0xffff0000, v32
  v_lshlrev_b32 v66, 16, v33
  v_and_b32 v67, 0xffff0000, v33
  v_lshlrev_b32 v68, 16, v34
  v_and_b32 v69, 0xffff0000, v34
  v_lshlrev_b32 v70, 16, v35
  v_and_b32 v71, 0xffff0000, v35
  v_lshlrev_b32 v72, 16, v36
  v_and_b32 v73, 0xffff0000, v36
  v_lshlrev_b32 v74, 16, v37
  v_and_b32 v75, 0xffff0000, v37
  v_lshlrev_b32 v76, 16, v38
  v_and_b32 v77, 0xffff0000, v38
  v_lshlrev_b32 v78, 16, v39
  v_and_b32 v79, 0xffff0000, v39
  s_nop 1
  v_add_f32_dpp v6, v6, v6 row_ror:8 row_mask:0xf bank_mask:0xf
  s_nop 1
  v_add_f32_dpp v6, v6, v6 row_ror:4 row_mask:0xf bank_mask:0xf
  s_nop 1
  v_add_f32_dpp v6, v6, v6 row_ror:2 row_mask:0xf bank_mask:0xf
  s_nop 1
  v_add_f32_dpp v6, v6, v6 row_ror:1 row_mask:0xf bank_mask:0xf
  v_mul_f32 v6, 0x3acccccd, v6
  v_mov_b32 v7, v6
  v_pk_add_f32 v[40:41], v[40:41], v[6:7] neg_lo:[0,1] neg_hi:[0,1]
  v_pk_add_f32 v[42:43], v[42:43], v[6:7] neg_lo:[0,1] neg_hi:[0,1]
  v_pk_add_f32 v[44:45], v[44:45], v[6:7] neg_lo:[0,1] neg_hi:[0,1]
  v_pk_add_f32 v[46:47], v[46:47], v[6:7] neg_lo:[0,1] neg_hi:[0,1]
  v_pk_add_f32 v[48:49], v[48:49], v[6:7] neg_lo:[0,1] neg_hi:[0,1]
  v_pk_add_f32 v[50:51], v[50:51], v[6:7] neg_lo:[0,1] neg_hi:[0,1]
  v_pk_add_f32 v[52:53], v[52:53], v[6:7] neg_lo:[0,1] neg_hi:[0,1]
  v_pk_add_f32 v[54:55], v[54:55], v[6:7] neg_lo:[0,1] neg_hi:[0,1]
  v_pk_add_f32 v[56:57], v[56:57], v[6:7] neg_lo:[0,1] neg_hi:[0,1]
  v_pk_add_f32 v[58:59], v[58:59], v[6:7] neg_lo:[0,1] neg_hi:[0,1]
  v_pk_add_f32 v[60:61], v[60:61], v[6:7] neg_lo:[0,1] neg_hi:[0,1]
  v_pk_add_f32 v[62:63], v[62:63], v[6:7] neg_lo:[0,1] neg_hi:[0,1]
  v_pk_add_f32 v[64:65], v[64:65], v[6:7] neg_lo:[0,1] neg_hi:[0,1]
  v_pk_add_f32 v[66:67], v[66:67], v[6:7] neg_lo:[0,1] neg_hi:[0,1]
  v_pk_add_f32 v[68:69], v[68:69], v[6:7] neg_lo:[0,1] neg_hi:[0,1]
  v_pk_add_f32 v[70:71], v[70:71], v[6:7] neg_lo:[0,1] neg_hi:[0,1]
  v_pk_add_f32 v[72:73], v[72:73], v[6:7] neg_lo:[0,1] neg_hi:[0,1]
  v_pk_add_f32 v[74:75], v[74:75], v[6:7] neg_lo:[0,1] neg_hi:[0,1]
  v_pk_add_f32 v[76:77], v[76:77], v[6:7] neg_lo:[0,1] neg_hi:[0,1]
  v_pk_add_f32 v[78:79], v[78:79], v[6:7] neg_lo:[0,1] neg_hi:[0,1]
  v_pk_fma_f32 v[8:9], v[40:41], v[40:41], v[8:9]
  v_pk_fma_f32 v[8:9], v[42:43], v[42:43], v[8:9]
  v_pk_fma_f32 v[8:9], v[44:45], v[44:45], v[8:9]
  v_pk_fma_f32 v[8:9], v[46:47], v[46:47], v[8:9]
  v_pk_fma_f32 v[8:9], v[48:49], v[48:49], v[8:9]
  v_pk_fma_f32 v[8:9], v[50:51], v[50:51], v[8:9]
  v_pk_fma_f32 v[8:9], v[52:53], v[52:53], v[8:9]
  v_pk_fma_f32 v[8:9], v[54:55], v[54:55], v[8:9]
  v_pk_fma_f32 v[8:9], v[56:57], v[56:57], v[8:9]
  v_pk_fma_f32 v[8:9], v[58:59], v[58:59], v[8:9]
  v_pk_fma_f32 v[8:9], v[60:61], v[60:61], v[8:9]
  v_pk_fma_f32 v[8:9], v[62:63], v[62:63], v[8:9]
  v_pk_fma_f32 v[8:9], v[64:65], v[64:65], v[8:9]
  v_pk_fma_f32 v[8:9], v[66:67], v[66:67], v[8:9]
  v_pk_fma_f32 v[8:9], v[68:69], v[68:69], v[8:9]
  v_pk_fma_f32 v[8:9], v[70:71], v[70:71], v[8:9]
  v_pk_fma_f32 v[8:9], v[72:73], v[72:73], v[8:9]
  v_pk_fma_f32 v[8:9], v[74:75], v[74:75], v[8:9]
  v_pk_fma_f32 v[8:9], v[76:77], v[76:77], v[8:9]
  v_pk_fma_f32 v[8:9], v[78:79], v[78:79], v[8:9]
  v_add_f32 v8, v8, v9
  s_nop 1
  v_add_f32_dpp v8, v8, v8 row_ror:8 row_mask:0xf bank_mask:0xf
  s_nop 1
  v_add_f32_dpp v8, v8, v8 row_ror:4 row_mask:0xf bank_mask:0xf
  s_nop 1
  v_add_f32_dpp v8, v8, v8 row_ror:2 row_mask:0xf bank_mask:0xf
  s_nop 1
  v_add_f32_dpp v8, v8, v8 row_ror:1 row_mask:0xf bank_mask:0xf
  v_mul_f32 v8, 0x3acccccd, v8
  v_cvt_pk_bf16_f32 v10, v6, v8
  v_lshlrev_b32 v6, 16, v10
  v_and_b32 v8, 0xffff0000, v10
  v_add_f32 v8, 0x3727c5ac, v8
  v_cvt_pk_bf16_f32 v8, v8, v8
  v_lshlrev_b32 v8, 16, v8
  v_sqrt_f32 v8, v8
  s_nop 0
  v_cvt_pk_bf16_f32 v8, v8, v8
  v_lshlrev_b32 v3, 1, v3
  s_mov_b32 s46, 17825792
  s_mov_b32 s47, 17829888
  buffer_store_short v10, v3, s[36:39], s46 offen
  buffer_store_short v8, v3, s[36:39], s47 offen
prep_dump:
prep_kernel_end:
  s_endpgm
.globl conv_kernel
.p2align 8
.type conv_kernel,@function
conv_kernel:
  s_cmp_ge_u32 s2, 736
  v_readfirstlane_b32 s96, v0
  s_cbranch_scc1 conv_kernel_end
  s_load_dwordx4 s[4:7], s[0:1], 32
  s_load_dwordx2 s[16:17], s[0:1], 96
  s_load_dwordx4 s[12:15], s[0:1], 56
  s_load_dwordx2 s[8:9], s[0:1], 72
  s_mov_b32 s51, s2
  s_sub_u32 s2, s2, 640
  s_cmp_ge_u32 s51, 640
  s_cbranch_scc1 conv_c
  s_mov_b32 s2, s51
  v_lshlrev_b32 v1, 4, v0
  v_lshlrev_b32 v2, 5, v0
  s_lshl_b32 s3, s51, 12
  s_lshr_b32 s18, s51, 1
  s_lshl_b32 s18, s18, 2
  s_mul_i32 s49, s51, 4352
  s_add_u32 s19, s49, 2818048
  s_add_u32 s44, s49, 5636096
  s_mov_b32 s45, 17825792
  s_mov_b32 s46, 17829888
  s_waitcnt lgkmcnt(0)
  s_mov_b32 s36, s16
  s_and_b32 s37, s17, 0xffff
  s_mov_b32 s38, 268435456
  s_mov_b32 s39, 0x00020000
  s_mov_b32 s20, s4
  s_and_b32 s21, s5, 0xffff
  s_mov_b32 s22, 2621440
  s_mov_b32 s23, 0x00020000
  buffer_load_dwordx4 v[4:7], v1, s[36:39], s49 offen
  buffer_load_dwordx4 v[8:11], v1, s[20:23], s3 offen
  s_load_dword s52, s[6:7], s18
  s_mov_b32 s28, s8
  s_and_b32 s29, s9, 0xffff
  s_mov_b32 s30, 1966080
  s_mov_b32 s31, 0x00020000
  v_mov_b32 v40, 0
  v_mov_b32 v41, 0
  v_mov_b32 v42, 0
  v_mov_b32 v43, 0
  v_and_b32 v34, 7, v0
  v_lshlrev_b32 v34, 4, v34
  v_bfe_u32 v35, v0, 3, 2
  s_movk_i32 s47, 1344
  v_mad_u32_u24 v35, v35, s47, v34
  v_add_u32 v35, 5248, v35
  ds_write_b128 v34, v[40:43]
  ds_write_b128 v35, v[40:43]
  v_and_b32 v36, 3, v0
  s_movk_i32 s48, 8208
  v_mul_u32_u24 v36, s48, v36
  ds_write_b128 v36, v[40:43] offset:9600
  v_lshrrev_b32 v37, 6, v0
  v_bfe_u32 v38, v0, 4, 2
  v_bfe_u32 v39, v0, 2, 2
  v_and_b32 v33, 3, v0
  v_add_u32 v44, v39, v33
  v_lshlrev_b32 v44, 3, v44
  v_lshl_add_u32 v44, v37, 5, v44
  v_lshl_add_u32 v44, v38, 6, v44
  v_add_u32 v44, 8, v44
  v_mul_u32_u24 v45, s47, v33
  v_lshl_add_u32 v45, v38, 4, v45
  v_lshlrev_b32 v46, 5, v39
  v_sub_u32 v45, v45, v46
  v_add_u32 v45, 4320, v45
  v_lshl_add_u32 v46, v39, 8, v36
  v_lshl_add_u32 v46, v37, 6, v46
  v_lshl_add_u32 v46, v38, 4, v46
  v_lshlrev_b32 v47, 2, v0
  v_sub_u32 v47, 5244, v47
  s_mov_b32 s56, 0x05040100
  s_mov_b32 s57, 0x07060302
  s_waitcnt vmcnt(1)
  ds_write_b128 v1, v[4:7] offset:128
  s_waitcnt vmcnt(0)
  v_perm_b32 v40, v8, v10, s56
  ds_write_b32 v47, v40 offset:0
  v_perm_b32 v41, v8, v10, s57
  ds_write_b32 v47, v41 offset:1344
  v_perm_b32 v42, v9, v11, s56
  ds_write_b32 v47, v42 offset:2688
  v_perm_b32 v43, v9, v11, s57
  ds_write_b32 v47, v43 offset:4032
  s_waitcnt lgkmcnt(0)
  s_barrier
  ds_read_b64_tr_b16 v[48:49], v44 offset:0
  ds_read_b64_tr_b16 v[50:51], v44 offset:32
  ds_read_b128 v[68:71], v45 offset:896
  ds_read_b128 v[76:79], v45 offset:768
  ds_read_b128 v[84:87], v45 offset:640
  ds_read_b128 v[92:95], v45 offset:512
  ds_read_b128 v[100:103], v45 offset:384
  ds_read_b128 v[108:111], v45 offset:256
  ds_read_b128 v[116:119], v45 offset:128
  ds_read_b128 v[124:127], v45 offset:0
  ds_read_b64_tr_b16 v[52:53], v44 offset:256
  ds_read_b64_tr_b16 v[54:55], v44 offset:288
  ds_read_b128 v[64:67], v45 offset:960
  ds_read_b128 v[72:75], v45 offset:832
  ds_read_b128 v[80:83], v45 offset:704
  ds_read_b128 v[88:91], v45 offset:576
  ds_read_b128 v[96:99], v45 offset:448
  ds_read_b128 v[104:107], v45 offset:320
  ds_read_b128 v[112:115], v45 offset:192
  ds_read_b128 v[120:123], v45 offset:64
  ds_read_b64_tr_b16 v[56:57], v44 offset:512
  ds_read_b64_tr_b16 v[58:59], v44 offset:544
  buffer_load_dwordx4 v[12:15], v1, s[36:39], s19 offen
  buffer_load_dwordx4 v[8:11], v1, s[36:39], s45 offen
  buffer_load_dwordx4 v[40:43], v1, s[36:39], s46 offen
  s_mul_i32 s50, s51, 3072
  v_add_u32 v33, s50, v1
  buffer_load_dwordx4 v[160:163], v33, s[28:31], 0 offen
  s_waitcnt lgkmcnt(12)
  v_mfma_f32_16x16x32_bf16 v[128:131], v[48:51], v[68:71], 0
  v_mfma_f32_16x16x32_bf16 v[132:135], v[48:51], v[76:79], 0
  v_mfma_f32_16x16x32_bf16 v[136:139], v[48:51], v[84:87], 0
  v_mfma_f32_16x16x32_bf16 v[140:143], v[48:51], v[92:95], 0
  v_mfma_f32_16x16x32_bf16 v[144:147], v[48:51], v[100:103], 0
  v_mfma_f32_16x16x32_bf16 v[148:151], v[48:51], v[108:111], 0
  v_mfma_f32_16x16x32_bf16 v[152:155], v[48:51], v[116:119], 0
  v_mfma_f32_16x16x32_bf16 v[156:159], v[48:51], v[124:127], 0
  ds_read_b64_tr_b16 v[60:61], v44 offset:768
  ds_read_b64_tr_b16 v[62:63], v44 offset:800
  s_waitcnt lgkmcnt(4)
  v_mfma_f32_16x16x32_bf16 v[128:131], v[52:55], v[64:67], v[128:131]
  v_mfma_f32_16x16x32_bf16 v[132:135], v[52:55], v[72:75], v[132:135]
  v_mfma_f32_16x16x32_bf16 v[136:139], v[52:55], v[80:83], v[136:139]
  v_mfma_f32_16x16x32_bf16 v[140:143], v[52:55], v[88:91], v[140:143]
  v_mfma_f32_16x16x32_bf16 v[144:147], v[52:55], v[96:99], v[144:147]
  v_mfma_f32_16x16x32_bf16 v[148:151], v[52:55], v[104:107], v[148:151]
  v_mfma_f32_16x16x32_bf16 v[152:155], v[52:55], v[112:115], v[152:155]
  v_mfma_f32_16x16x32_bf16 v[156:159], v[52:55], v[120:123], v[156:159]
  ds_read_b64_tr_b16 v[48:49], v44 offset:1024
  ds_read_b64_tr_b16 v[50:51], v44 offset:1056
  s_waitcnt lgkmcnt(4)
  v_mfma_f32_16x16x32_bf16 v[132:135], v[56:59], v[68:71], v[132:135]
  v_mfma_f32_16x16x32_bf16 v[136:139], v[56:59], v[76:79], v[136:139]
  v_mfma_f32_16x16x32_bf16 v[140:143], v[56:59], v[84:87], v[140:143]
  v_mfma_f32_16x16x32_bf16 v[144:147], v[56:59], v[92:95], v[144:147]
  v_mfma_f32_16x16x32_bf16 v[148:151], v[56:59], v[100:103], v[148:151]
  v_mfma_f32_16x16x32_bf16 v[152:155], v[56:59], v[108:111], v[152:155]
  v_mfma_f32_16x16x32_bf16 v[156:159], v[56:59], v[116:119], v[156:159]
  ds_read_b64_tr_b16 v[52:53], v44 offset:1280
  ds_read_b64_tr_b16 v[54:55], v44 offset:1312
  s_waitcnt lgkmcnt(4)
  v_mfma_f32_16x16x32_bf16 v[132:135], v[60:63], v[64:67], v[132:135]
  v_mfma_f32_16x16x32_bf16 v[136:139], v[60:63], v[72:75], v[136:139]
  v_mfma_f32_16x16x32_bf16 v[140:143], v[60:63], v[80:83], v[140:143]
  v_mfma_f32_16x16x32_bf16 v[144:147], v[60:63], v[88:91], v[144:147]
  v_mfma_f32_16x16x32_bf16 v[148:151], v[60:63], v[96:99], v[148:151]
  v_mfma_f32_16x16x32_bf16 v[152:155], v[60:63], v[104:107], v[152:155]
  v_mfma_f32_16x16x32_bf16 v[156:159], v[60:63], v[112:115], v[156:159]
  ds_write_b128 v46, v[128:131] offset:9616
  ds_read_b64_tr_b16 v[56:57], v44 offset:1536
  ds_read_b64_tr_b16 v[58:59], v44 offset:1568
  s_waitcnt lgkmcnt(4)
  v_mfma_f32_16x16x32_bf16 v[136:139], v[48:51], v[68:71], v[136:139]
  v_mfma_f32_16x16x32_bf16 v[140:143], v[48:51], v[76:79], v[140:143]
  v_mfma_f32_16x16x32_bf16 v[144:147], v[48:51], v[84:87], v[144:147]
  v_mfma_f32_16x16x32_bf16 v[148:151], v[48:51], v[92:95], v[148:151]
  v_mfma_f32_16x16x32_bf16 v[152:155], v[48:51], v[100:103], v[152:155]
  v_mfma_f32_16x16x32_bf16 v[156:159], v[48:51], v[108:111], v[156:159]
  ds_read_b64_tr_b16 v[60:61], v44 offset:1792
  ds_read_b64_tr_b16 v[62:63], v44 offset:1824
  s_waitcnt lgkmcnt(4)
  v_mfma_f32_16x16x32_bf16 v[136:139], v[52:55], v[64:67], v[136:139]
  v_mfma_f32_16x16x32_bf16 v[140:143], v[52:55], v[72:75], v[140:143]
  v_mfma_f32_16x16x32_bf16 v[144:147], v[52:55], v[80:83], v[144:147]
  v_mfma_f32_16x16x32_bf16 v[148:151], v[52:55], v[88:91], v[148:151]
  v_mfma_f32_16x16x32_bf16 v[152:155], v[52:55], v[96:99], v[152:155]
  v_mfma_f32_16x16x32_bf16 v[156:159], v[52:55], v[104:107], v[156:159]
  ds_write_b128 v46, v[132:135] offset:10640
  ds_read_b64_tr_b16 v[48:49], v44 offset:2048
  ds_read_b64_tr_b16 v[50:51], v44 offset:2080
  s_waitcnt lgkmcnt(4)
  v_mfma_f32_16x16x32_bf16 v[140:143], v[56:59], v[68:71], v[140:143]
  v_mfma_f32_16x16x32_bf16 v[144:147], v[56:59], v[76:79], v[144:147]
  v_mfma_f32_16x16x32_bf16 v[148:151], v[56:59], v[84:87], v[148:151]
  v_mfma_f32_16x16x32_bf16 v[152:155], v[56:59], v[92:95], v[152:155]
  v_mfma_f32_16x16x32_bf16 v[156:159], v[56:59], v[100:103], v[156:159]
  ds_read_b64_tr_b16 v[52:53], v44 offset:2304
  ds_read_b64_tr_b16 v[54:55], v44 offset:2336
  s_waitcnt lgkmcnt(4)
  v_mfma_f32_16x16x32_bf16 v[140:143], v[60:63], v[64:67], v[140:143]
  v_mfma_f32_16x16x32_bf16 v[144:147], v[60:63], v[72:75], v[144:147]
  v_mfma_f32_16x16x32_bf16 v[148:151], v[60:63], v[80:83], v[148:151]
  v_mfma_f32_16x16x32_bf16 v[152:155], v[60:63], v[88:91], v[152:155]
  v_mfma_f32_16x16x32_bf16 v[156:159], v[60:63], v[96:99], v[156:159]
  ds_write_b128 v46, v[136:139] offset:11664
  ds_read_b64_tr_b16 v[56:57], v44 offset:2560
  ds_read_b64_tr_b16 v[58:59], v44 offset:2592
  s_waitcnt lgkmcnt(4)
  v_mfma_f32_16x16x32_bf16 v[144:147], v[48:51], v[68:71], v[144:147]
  v_mfma_f32_16x16x32_bf16 v[148:151], v[48:51], v[76:79], v[148:151]
  v_mfma_f32_16x16x32_bf16 v[152:155], v[48:51], v[84:87], v[152:155]
  v_mfma_f32_16x16x32_bf16 v[156:159], v[48:51], v[92:95], v[156:159]
  ds_read_b64_tr_b16 v[60:61], v44 offset:2816
  ds_read_b64_tr_b16 v[62:63], v44 offset:2848
  s_waitcnt lgkmcnt(4)
  v_mfma_f32_16x16x32_bf16 v[144:147], v[52:55], v[64:67], v[144:147]
  v_mfma_f32_16x16x32_bf16 v[148:151], v[52:55], v[72:75], v[148:151]
  v_mfma_f32_16x16x32_bf16 v[152:155], v[52:55], v[80:83], v[152:155]
  v_mfma_f32_16x16x32_bf16 v[156:159], v[52:55], v[88:91], v[156:159]
  ds_write_b128 v46, v[140:143] offset:12688
  ds_read_b64_tr_b16 v[48:49], v44 offset:3072
  ds_read_b64_tr_b16 v[50:51], v44 offset:3104
  s_waitcnt lgkmcnt(4)
  v_mfma_f32_16x16x32_bf16 v[148:151], v[56:59], v[68:71], v[148:151]
  v_mfma_f32_16x16x32_bf16 v[152:155], v[56:59], v[76:79], v[152:155]
  v_mfma_f32_16x16x32_bf16 v[156:159], v[56:59], v[84:87], v[156:159]
  ds_read_b64_tr_b16 v[52:53], v44 offset:3328
  ds_read_b64_tr_b16 v[54:55], v44 offset:3360
  s_waitcnt lgkmcnt(4)
  v_mfma_f32_16x16x32_bf16 v[148:151], v[60:63], v[64:67], v[148:151]
  v_mfma_f32_16x16x32_bf16 v[152:155], v[60:63], v[72:75], v[152:155]
  v_mfma_f32_16x16x32_bf16 v[156:159], v[60:63], v[80:83], v[156:159]
  ds_write_b128 v46, v[144:147] offset:13712
  ds_read_b64_tr_b16 v[56:57], v44 offset:3584
  ds_read_b64_tr_b16 v[58:59], v44 offset:3616
  s_waitcnt lgkmcnt(4)
  v_mfma_f32_16x16x32_bf16 v[152:155], v[48:51], v[68:71], v[152:155]
  v_mfma_f32_16x16x32_bf16 v[156:159], v[48:51], v[76:79], v[156:159]
  ds_read_b64_tr_b16 v[60:61], v44 offset:3840
  ds_read_b64_tr_b16 v[62:63], v44 offset:3872
  s_waitcnt lgkmcnt(4)
  v_mfma_f32_16x16x32_bf16 v[152:155], v[52:55], v[64:67], v[152:155]
  v_mfma_f32_16x16x32_bf16 v[156:159], v[52:55], v[72:75], v[156:159]
  ds_write_b128 v46, v[148:151] offset:14736
  s_waitcnt lgkmcnt(2)
  v_mfma_f32_16x16x32_bf16 v[156:159], v[56:59], v[68:71], v[156:159]
  s_waitcnt lgkmcnt(0)
  v_mfma_f32_16x16x32_bf16 v[156:159], v[60:63], v[64:67], v[156:159]
  ds_write_b128 v46, v[152:155] offset:15760
  s_nop 7
  s_nop 1
  ds_write_b128 v46, v[156:159] offset:16784
  s_waitcnt vmcnt(1)
  v_lshlrev_b32 v24, 16, v40
  v_and_b32 v25, 0xffff0000, v40
  v_lshlrev_b32 v26, 16, v41
  v_and_b32 v27, 0xffff0000, v41
  v_lshlrev_b32 v28, 16, v42
  v_and_b32 v29, 0xffff0000, v42
  v_lshlrev_b32 v30, 16, v43
  v_and_b32 v31, 0xffff0000, v43
  v_rcp_f32 v24, v24
  v_rcp_f32 v25, v25
  v_rcp_f32 v26, v26
  v_rcp_f32 v27, v27
  v_rcp_f32 v28, v28
  v_rcp_f32 v29, v29
  v_rcp_f32 v30, v30
  v_rcp_f32 v31, v31
  v_lshlrev_b32 v112, 16, v4
  v_and_b32 v113, 0xffff0000, v4
  v_lshlrev_b32 v120, 16, v12
  v_and_b32 v121, 0xffff0000, v12
  v_lshlrev_b32 v16, 16, v8
  v_and_b32 v17, 0xffff0000, v8
  v_lshlrev_b32 v114, 16, v5
  v_and_b32 v115, 0xffff0000, v5
  v_lshlrev_b32 v122, 16, v13
  v_and_b32 v123, 0xffff0000, v13
  v_lshlrev_b32 v18, 16, v9
  v_and_b32 v19, 0xffff0000, v9
  v_lshlrev_b32 v116, 16, v6
  v_and_b32 v117, 0xffff0000, v6
  v_lshlrev_b32 v124, 16, v14
  v_and_b32 v125, 0xffff0000, v14
  v_lshlrev_b32 v20, 16, v10
  v_and_b32 v21, 0xffff0000, v10
  v_lshlrev_b32 v118, 16, v7
  v_and_b32 v119, 0xffff0000, v7
  v_lshlrev_b32 v126, 16, v15
  v_and_b32 v127, 0xffff0000, v15
  v_lshlrev_b32 v22, 16, v11
  v_and_b32 v23, 0xffff0000, v11
  s_lshl_b32 s53, s52, 16
  s_and_b32 s52, s52, 0xffff0000
  s_bitcmp1_b32 s51, 0
  s_cselect_b32 s52, s52, s53
  v_mov_b32 v32, s52
  v_mov_b32 v33, s52
  v_sub_f32 v16, v120, v16
  v_sub_f32 v17, v121, v17
  v_sub_f32 v18, v122, v18
  v_sub_f32 v19, v123, v19
  v_sub_f32 v20, v124, v20
  v_sub_f32 v21, v125, v21
  v_sub_f32 v22, v126, v22
  v_sub_f32 v23, v127, v23
  v_mul_f32 v16, v16, v24
  v_mul_f32 v17, v17, v25
  v_mul_f32 v18, v18, v26
  v_mul_f32 v19, v19, v27
  v_mul_f32 v20, v20, v28
  v_mul_f32 v21, v21, v29
  v_mul_f32 v22, v22, v30
  v_mul_f32 v23, v23, v31
  s_waitcnt lgkmcnt(0)
  s_barrier
  ds_read_b128 v[48:51], v2 offset:9616
  ds_read_b128 v[52:55], v2 offset:9632
  ds_read_b128 v[68:71], v2 offset:26016
  ds_read_b128 v[72:75], v2 offset:26032
  ds_read_b128 v[76:79], v2 offset:26048
  ds_read_b128 v[56:59], v2 offset:17808
  ds_read_b128 v[60:63], v2 offset:17824
  ds_read_b128 v[64:67], v2 offset:17840
  ds_read_b128 v[80:83], v2 offset:34224
  ds_read_b128 v[84:87], v2 offset:34240
  ds_read_b128 v[88:91], v2 offset:34256
  s_waitcnt lgkmcnt(9)
  v_pk_fma_f32 v[48:49], v[112:113], v[32:33], v[48:49]
  v_pk_fma_f32 v[50:51], v[114:115], v[32:33], v[50:51]
  v_pk_fma_f32 v[52:53], v[116:117], v[32:33], v[52:53]
  v_pk_fma_f32 v[54:55], v[118:119], v[32:33], v[54:55]
  s_waitcnt lgkmcnt(6)
  v_pk_add_f32 v[48:49], v[48:49], v[70:71]
  v_pk_add_f32 v[50:51], v[50:51], v[72:73]
  v_pk_add_f32 v[52:53], v[52:53], v[74:75]
  v_pk_add_f32 v[54:55], v[54:55], v[76:77]
  s_waitcnt lgkmcnt(3)
  v_add_f32 v48, v48, v59
  v_add_f32 v49, v49, v60
  v_add_f32 v50, v50, v61
  v_add_f32 v51, v51, v62
  v_add_f32 v52, v52, v63
  v_add_f32 v53, v53, v64
  v_add_f32 v54, v54, v65
  v_add_f32 v55, v55, v66
  s_waitcnt lgkmcnt(0)
  v_add_f32 v48, v48, v81
  v_add_f32 v49, v49, v82
  v_add_f32 v50, v50, v83
  v_add_f32 v51, v51, v84
  v_add_f32 v52, v52, v85
  v_add_f32 v53, v53, v86
  v_add_f32 v54, v54, v87
  v_add_f32 v55, v55, v88
  v_pk_fma_f32 v[48:49], v[48:49], v[16:17], v[120:121]
  v_pk_fma_f32 v[50:51], v[50:51], v[18:19], v[122:123]
  v_pk_fma_f32 v[52:53], v[52:53], v[20:21], v[124:125]
  v_pk_fma_f32 v[54:55], v[54:55], v[22:23], v[126:127]
  v_cvt_pk_bf16_f32 v4, v48, v49
  v_cvt_pk_bf16_f32 v5, v50, v51
  v_cvt_pk_bf16_f32 v6, v52, v53
  v_cvt_pk_bf16_f32 v7, v54, v55
  buffer_store_dwordx4 v[4:7], v1, s[36:39], s44 offen
  s_cmp_ge_u32 s96, 192
  s_cbranch_scc1 conv_nost
  s_mul_i32 s50, s51, 192
  v_add_u32 v48, s50, v0
  v_lshrrev_b32 v49, 4, v48
  s_mov_b32 s50, 52429
  v_mul_u32_u24 v49, s50, v49
  v_lshrrev_b32 v49, 18, v49
  s_movk_i32 s50, 80
  v_mul_u32_u24 v50, s50, v49
  v_sub_u32 v50, v48, v50
  s_movk_i32 s50, 205
  v_mul_u32_u24 v51, s50, v50
  v_lshrrev_b32 v51, 11, v51
  s_movk_i32 s50, 4960
  v_mul_u32_u24 v51, s50, v51
  v_lshl_add_u32 v51, v50, 4, v51
  v_lshrrev_b32 v50, 5, v49
  s_mov_b32 s50, 40960
  v_mad_u32_u24 v51, v50, s50, v51
  v_and_b32 v49, 31, v49
  s_movk_i32 s50, 160
  v_mad_u32_u24 v51, v49, s50, v51
  s_mov_b32 s50, 18874368
  s_waitcnt vmcnt(1)
  buffer_store_dwordx4 v[160:163], v51, s[36:39], s50 offen
conv_nost:
  s_endpgm
conv_c:
  s_lshr_b32 s3, s2, 1
  s_and_b32 s19, s2, 1
  s_waitcnt lgkmcnt(0)
  s_cmp_ge_u32 s3, 24
  s_cselect_b32 s12, s14, s12
  s_cselect_b32 s13, s15, s13
  s_cselect_b32 s18, 24, 0
  s_sub_u32 s18, s3, s18
  s_mov_b32 s40, s12
  s_and_b32 s41, s13, 0xffff
  s_mov_b32 s42, 1966080
  s_mov_b32 s43, 0x00020000
  s_mov_b32 s36, s16
  s_and_b32 s37, s17, 0xffff
  s_mov_b32 s38, 268435456
  s_mov_b32 s39, 0x00020000
  v_and_b32 v1, 7, v0
  v_lshrrev_b32 v2, 3, v0
  s_lshl_b32 s18, s18, 7
  s_mul_i32 s45, s19, 983040
  s_add_u32 s18, s18, s45
  v_lshl_add_u32 v4, v1, 4, s18
  s_movk_i32 s44, 30720
  v_mad_u32_u24 v5, v2, s44, v4
  s_mov_b32 s48, 0
  buffer_load_dwordx4 v[20:23], v5, s[40:43], s48 offen
  s_mov_b32 s49, 3072
  buffer_load_dwordx4 v[24:27], v5, s[40:43], s49 offen
  s_mov_b32 s50, 6144
  buffer_load_dwordx4 v[28:31], v5, s[40:43], s50 offen
  s_mov_b32 s51, 9216
  buffer_load_dwordx4 v[32:35], v5, s[40:43], s51 offen
  s_mov_b32 s52, 12288
  buffer_load_dwordx4 v[36:39], v5, s[40:43], s52 offen
  s_mov_b32 s53, 15360
  buffer_load_dwordx4 v[40:43], v5, s[40:43], s53 offen
  s_mov_b32 s54, 18432
  buffer_load_dwordx4 v[44:47], v5, s[40:43], s54 offen
  s_mov_b32 s55, 21504
  buffer_load_dwordx4 v[48:51], v5, s[40:43], s55 offen
  s_mov_b32 s56, 24576
  buffer_load_dwordx4 v[52:55], v5, s[40:43], s56 offen
  s_mov_b32 s57, 27648
  buffer_load_dwordx4 v[56:59], v5, s[40:43], s57 offen
  s_waitcnt vmcnt(9)
  v_lshlrev_b32 v8, 16, v20
  v_and_b32 v9, 0xffff0000, v20
  v_lshlrev_b32 v10, 16, v21
  v_and_b32 v11, 0xffff0000, v21
  v_lshlrev_b32 v12, 16, v22
  v_and_b32 v13, 0xffff0000, v22
  v_lshlrev_b32 v14, 16, v23
  v_and_b32 v15, 0xffff0000, v23
  s_waitcnt vmcnt(8)
  v_lshlrev_b32 v60, 16, v24
  v_and_b32 v61, 0xffff0000, v24
  v_lshlrev_b32 v62, 16, v25
  v_and_b32 v63, 0xffff0000, v25
  v_lshlrev_b32 v64, 16, v26
  v_and_b32 v65, 0xffff0000, v26
  v_lshlrev_b32 v66, 16, v27
  v_and_b32 v67, 0xffff0000, v27
  v_add_f32 v8, v8, v60
  v_add_f32 v9, v9, v61
  v_add_f32 v10, v10, v62
  v_add_f32 v11, v11, v63
  v_add_f32 v12, v12, v64
  v_add_f32 v13, v13, v65
  v_add_f32 v14, v14, v66
  v_add_f32 v15, v15, v67
  s_waitcnt vmcnt(7)
  v_lshlrev_b32 v60, 16, v28
  v_and_b32 v61, 0xffff0000, v28
  v_lshlrev_b32 v62, 16, v29
  v_and_b32 v63, 0xffff0000, v29
  v_lshlrev_b32 v64, 16, v30
  v_and_b32 v65, 0xffff0000, v30
  v_lshlrev_b32 v66, 16, v31
  v_and_b32 v67, 0xffff0000, v31
  v_add_f32 v8, v8, v60
  v_add_f32 v9, v9, v61
  v_add_f32 v10, v10, v62
  v_add_f32 v11, v11, v63
  v_add_f32 v12, v12, v64
  v_add_f32 v13, v13, v65
  v_add_f32 v14, v14, v66
  v_add_f32 v15, v15, v67
  s_waitcnt vmcnt(6)
  v_lshlrev_b32 v60, 16, v32
  v_and_b32 v61, 0xffff0000, v32
  v_lshlrev_b32 v62, 16, v33
  v_and_b32 v63, 0xffff0000, v33
  v_lshlrev_b32 v64, 16, v34
  v_and_b32 v65, 0xffff0000, v34
  v_lshlrev_b32 v66, 16, v35
  v_and_b32 v67, 0xffff0000, v35
  v_add_f32 v8, v8, v60
  v_add_f32 v9, v9, v61
  v_add_f32 v10, v10, v62
  v_add_f32 v11, v11, v63
  v_add_f32 v12, v12, v64
  v_add_f32 v13, v13, v65
  v_add_f32 v14, v14, v66
  v_add_f32 v15, v15, v67
  s_waitcnt vmcnt(5)
  v_lshlrev_b32 v60, 16, v36
  v_and_b32 v61, 0xffff0000, v36
  v_lshlrev_b32 v62, 16, v37
  v_and_b32 v63, 0xffff0000, v37
  v_lshlrev_b32 v64, 16, v38
  v_and_b32 v65, 0xffff0000, v38
  v_lshlrev_b32 v66, 16, v39
  v_and_b32 v67, 0xffff0000, v39
  v_add_f32 v8, v8, v60
  v_add_f32 v9, v9, v61
  v_add_f32 v10, v10, v62
  v_add_f32 v11, v11, v63
  v_add_f32 v12, v12, v64
  v_add_f32 v13, v13, v65
  v_add_f32 v14, v14, v66
  v_add_f32 v15, v15, v67
  s_waitcnt vmcnt(4)
  v_lshlrev_b32 v60, 16, v40
  v_and_b32 v61, 0xffff0000, v40
  v_lshlrev_b32 v62, 16, v41
  v_and_b32 v63, 0xffff0000, v41
  v_lshlrev_b32 v64, 16, v42
  v_and_b32 v65, 0xffff0000, v42
  v_lshlrev_b32 v66, 16, v43
  v_and_b32 v67, 0xffff0000, v43
  v_add_f32 v8, v8, v60
  v_add_f32 v9, v9, v61
  v_add_f32 v10, v10, v62
  v_add_f32 v11, v11, v63
  v_add_f32 v12, v12, v64
  v_add_f32 v13, v13, v65
  v_add_f32 v14, v14, v66
  v_add_f32 v15, v15, v67
  s_waitcnt vmcnt(3)
  v_lshlrev_b32 v60, 16, v44
  v_and_b32 v61, 0xffff0000, v44
  v_lshlrev_b32 v62, 16, v45
  v_and_b32 v63, 0xffff0000, v45
  v_lshlrev_b32 v64, 16, v46
  v_and_b32 v65, 0xffff0000, v46
  v_lshlrev_b32 v66, 16, v47
  v_and_b32 v67, 0xffff0000, v47
  v_add_f32 v8, v8, v60
  v_add_f32 v9, v9, v61
  v_add_f32 v10, v10, v62
  v_add_f32 v11, v11, v63
  v_add_f32 v12, v12, v64
  v_add_f32 v13, v13, v65
  v_add_f32 v14, v14, v66
  v_add_f32 v15, v15, v67
  s_waitcnt vmcnt(2)
  v_lshlrev_b32 v60, 16, v48
  v_and_b32 v61, 0xffff0000, v48
  v_lshlrev_b32 v62, 16, v49
  v_and_b32 v63, 0xffff0000, v49
  v_lshlrev_b32 v64, 16, v50
  v_and_b32 v65, 0xffff0000, v50
  v_lshlrev_b32 v66, 16, v51
  v_and_b32 v67, 0xffff0000, v51
  v_add_f32 v8, v8, v60
  v_add_f32 v9, v9, v61
  v_add_f32 v10, v10, v62
  v_add_f32 v11, v11, v63
  v_add_f32 v12, v12, v64
  v_add_f32 v13, v13, v65
  v_add_f32 v14, v14, v66
  v_add_f32 v15, v15, v67
  s_waitcnt vmcnt(1)
  v_lshlrev_b32 v60, 16, v52
  v_and_b32 v61, 0xffff0000, v52
  v_lshlrev_b32 v62, 16, v53
  v_and_b32 v63, 0xffff0000, v53
  v_lshlrev_b32 v64, 16, v54
  v_and_b32 v65, 0xffff0000, v54
  v_lshlrev_b32 v66, 16, v55
  v_and_b32 v67, 0xffff0000, v55
  v_add_f32 v8, v8, v60
  v_add_f32 v9, v9, v61
  v_add_f32 v10, v10, v62
  v_add_f32 v11, v11, v63
  v_add_f32 v12, v12, v64
  v_add_f32 v13, v13, v65
  v_add_f32 v14, v14, v66
  v_add_f32 v15, v15, v67
  s_waitcnt vmcnt(0)
  v_lshlrev_b32 v60, 16, v56
  v_and_b32 v61, 0xffff0000, v56
  v_lshlrev_b32 v62, 16, v57
  v_and_b32 v63, 0xffff0000, v57
  v_lshlrev_b32 v64, 16, v58
  v_and_b32 v65, 0xffff0000, v58
  v_lshlrev_b32 v66, 16, v59
  v_and_b32 v67, 0xffff0000, v59
  v_add_f32 v8, v8, v60
  v_add_f32 v9, v9, v61
  v_add_f32 v10, v10, v62
  v_add_f32 v11, v11, v63
  v_add_f32 v12, v12, v64
  v_add_f32 v13, v13, v65
  v_add_f32 v14, v14, v66
  v_add_f32 v15, v15, v67
  s_nop 1
  v_add_f32_dpp v8, v8, v8 row_ror:8 row_mask:0xf bank_mask:0xf
  v_add_f32_dpp v9, v9, v9 row_ror:8 row_mask:0xf bank_mask:0xf
  v_add_f32_dpp v10, v10, v10 row_ror:8 row_mask:0xf bank_mask:0xf
  v_add_f32_dpp v11, v11, v11 row_ror:8 row_mask:0xf bank_mask:0xf
  v_add_f32_dpp v12, v12, v12 row_ror:8 row_mask:0xf bank_mask:0xf
  v_add_f32_dpp v13, v13, v13 row_ror:8 row_mask:0xf bank_mask:0xf
  v_add_f32_dpp v14, v14, v14 row_ror:8 row_mask:0xf bank_mask:0xf
  v_add_f32_dpp v15, v15, v15 row_ror:8 row_mask:0xf bank_mask:0xf
  v_lshrrev_b32 v2, 4, v0
  v_lshlrev_b32 v2, 8, v2
  v_lshl_add_u32 v2, v1, 5, v2
  ds_write_b128 v2, v[8:11]
  ds_write_b128 v2, v[12:15] offset:16
  v_lshlrev_b32 v3, 2, v0
  s_waitcnt lgkmcnt(0)
  s_barrier
  s_cmp_ge_u32 s96, 64
  s_cbranch_scc1 conv_kernel_end
  ds_read2st64_b32 v[20:21], v3 offset0:0 offset1:8
  ds_read2st64_b32 v[22:23], v3 offset0:1 offset1:9
  ds_read2st64_b32 v[24:25], v3 offset0:2 offset1:10
  ds_read2st64_b32 v[26:27], v3 offset0:3 offset1:11
  ds_read2st64_b32 v[28:29], v3 offset0:4 offset1:12
  ds_read2st64_b32 v[30:31], v3 offset0:5 offset1:13
  ds_read2st64_b32 v[32:33], v3 offset0:6 offset1:14
  ds_read2st64_b32 v[34:35], v3 offset0:7 offset1:15
  s_lshl_b32 s3, s3, 8
  s_add_u32 s3, s3, 17842176
  s_mul_i32 s19, s19, 12288
  s_add_u32 s3, s3, s19
  s_waitcnt lgkmcnt(0)
  v_add_f32 v20, v20, v21
  v_add_f32 v20, v20, v22
  v_add_f32 v20, v20, v23
  v_add_f32 v20, v20, v24
  v_add_f32 v20, v20, v25
  v_add_f32 v20, v20, v26
  v_add_f32 v20, v20, v27
  v_add_f32 v20, v20, v28
  v_add_f32 v20, v20, v29
  v_add_f32 v20, v20, v30
  v_add_f32 v20, v20, v31
  v_add_f32 v20, v20, v32
  v_add_f32 v20, v20, v33
  v_add_f32 v20, v20, v34
  v_add_f32 v20, v20, v35
  buffer_store_dword v20, v3, s[36:39], s3 offen
conv_dump:
conv_kernel_end:
  s_endpgm
.globl gemm1_kernel
.p2align 8
.type gemm1_kernel,@function
gemm1_kernel:
  s_cmp_ge_u32 s2, 256
  v_readfirstlane_b32 s96, v0
  s_cbranch_scc1 gemm1_kernel_end
  s_load_dwordx4 s[12:15], s[0:1], 56
  s_load_dwordx2 s[16:17], s[0:1], 96
  s_lshr_b32 s8, s96, 6
  v_and_b32 v2, 63, v0
  s_and_b32 s3, s2, 3
  s_lshr_b32 s4, s2, 3
  s_and_b32 s5, s4, 3
  s_lshl_b32 s3, s3, 2
  s_add_u32 s3, s3, s5
  s_bfe_u32 s5, s2, 0x10002
  s_lshl_b32 s5, s5, 3
  s_lshr_b32 s4, s4, 2
  s_add_u32 s4, s4, s5
  s_and_b32 s9, s8, 3
  s_lshr_b32 s10, s8, 2
  v_lshrrev_b32 v3, 4, v2
  v_bfe_u32 v4, v2, 2, 2
  v_and_b32 v5, 3, v2
  v_and_b32 v6, 15, v2
  s_mul_i32 s6, s4, 192
  s_mov_b32 s66, 4294885376
  s_mov_b32 s50, 0
  s_mov_b32 s48, 0
  s_cmp_lt_u32 s8, 4
  s_cbranch_scc1 g1_cons
  s_movk_i32 s5, 4352
  s_lshl_b32 s7, s9, 4
  v_add_u32 v7, s7, v3
  v_mul_u32_u24 v7, s5, v7
  s_lshl_b32 s7, s3, 8
  v_add_u32 v7, s7, v7
  v_lshlrev_b32 v8, 1, v3
  v_xor_b32 v8, v8, v6
  v_lshl_add_u32 v14, v8, 4, v7
  v_xor_b32 v8, 8, v8
  v_lshl_add_u32 v15, v8, 4, v7
  v_add_u32 v15, 17408, v15
  s_lshl_b32 s5, s9, 4
  s_mov_b32 s7, 43691
  s_movk_i32 s11, 3072
  v_add_u32 v7, 0, v2
  v_mul_u32_u24 v8, s7, v7
  v_lshrrev_b32 v8, 19, v8
  v_mul_u32_u24 v9, 12, v8
  v_sub_u32 v9, v7, v9
  v_bfe_u32 v7, v8, 2, 1
  v_lshlrev_b32 v7, 1, v7
  v_xor_b32 v9, v9, v7
  v_add_u32 v8, s5, v8
  v_mul_u32_u24 v8, s11, v8
  v_lshl_add_u32 v16, v9, 4, v8
  v_add_u32 v16, s6, v16
  v_add_u32 v7, 64, v2
  v_mul_u32_u24 v8, s7, v7
  v_lshrrev_b32 v8, 19, v8
  v_mul_u32_u24 v9, 12, v8
  v_sub_u32 v9, v7, v9
  v_bfe_u32 v7, v8, 2, 1
  v_lshlrev_b32 v7, 1, v7
  v_xor_b32 v9, v9, v7
  v_add_u32 v8, s5, v8
  v_mul_u32_u24 v8, s11, v8
  v_lshl_add_u32 v17, v9, 4, v8
  v_add_u32 v17, s6, v17
  v_add_u32 v7, 128, v2
  v_mul_u32_u24 v8, s7, v7
  v_lshrrev_b32 v8, 19, v8
  v_mul_u32_u24 v9, 12, v8
  v_sub_u32 v9, v7, v9
  v_bfe_u32 v7, v8, 2, 1
  v_lshlrev_b32 v7, 1, v7
  v_xor_b32 v9, v9, v7
  v_add_u32 v8, s5, v8
  v_mul_u32_u24 v8, s11, v8
  v_lshl_add_u32 v18, v9, 4, v8
  v_add_u32 v18, s6, v18
  s_mov_b32 s44, 5636096
  s_mov_b32 s45, 0
  s_lshl_b32 s46, s9, 12
  s_mul_i32 s47, s9, 3072
  s_add_u32 s47, s47, 16384
  s_waitcnt lgkmcnt(0)
  s_mov_b32 s36, s16
  s_and_b32 s37, s17, 0xffff
  s_mov_b32 s38, 268435456
  s_mov_b32 s39, 0x00020000
  s_mov_b32 s40, s12
  s_and_b32 s41, s13, 0xffff
  s_mov_b32 s42, 1966080
  s_mov_b32 s43, 0x00020000
  s_mov_b32 s20, s14
  s_and_b32 s21, s15, 0xffff
  s_mov_b32 s22, 1966080
  s_mov_b32 s23, 0x00020000
g1_pro:
  s_add_u32 m0, s46, s48
  s_add_u32 s5, s44, 34816
  buffer_load_dwordx4 v14, s[36:39], s44 offen lds
  s_add_u32 m0, m0, 1024
  s_nop 0
  buffer_load_dwordx4 v15, s[36:39], s44 offen lds
  s_add_u32 m0, m0, 1024
  s_add_u32 s44, s44, 278528
  buffer_load_dwordx4 v14, s[36:39], s5 offen lds
  s_add_u32 m0, m0, 1024
  s_nop 0
  buffer_load_dwordx4 v15, s[36:39], s5 offen lds
  s_add_u32 m0, s47, s48
  s_nop 0
  buffer_load_dwordx4 v16, s[40:43], s45 offen lds
  s_add_u32 m0, m0, 1024
  s_nop 0
  buffer_load_dwordx4 v17, s[40:43], s45 offen lds
  s_add_u32 m0, m0, 1024
  s_nop 0
  buffer_load_dwordx4 v18, s[40:43], s45 offen lds
  s_add_u32 m0, m0, 10240
  s_nop 0
  buffer_load_dwordx4 v16, s[20:23], s45 offen lds
  s_add_u32 m0, m0, 1024
  s_nop 0
  buffer_load_dwordx4 v17, s[20:23], s45 offen lds
  s_add_u32 m0, m0, 1024
  s_nop 0
  buffer_load_dwordx4 v18, s[20:23], s45 offen lds
  s_add_u32 s45, s45, 196608
  s_cmp_eq_u32 s48, 81920
  s_cselect_b32 s51, s66, 40960
  s_add_u32 s48, s48, s51
  s_cmp_lg_u32 s48, 81920
  s_cbranch_scc1 g1_pro
  v_lshl_add_u32 v7, v3, 2, v4
  v_and_b32 v8, 7, v7
  s_lshl_b32 s5, s9, 1
  v_xor_b32 v8, s5, v8
  v_lshlrev_b32 v9, 3, v5
  v_lshl_add_u32 v10, v7, 8, v9
  v_lshl_add_u32 v10, v8, 5, v10
  v_xor_b32 v11, 32, v10
  s_mov_b32 s49, 0x3f803f80
  s_mov_b32 s52, 0
  v_mov_b32 v20, 0
  v_mov_b32 v21, 0
  v_mov_b32 v22, 0
  v_mov_b32 v23, 0
  v_mov_b32 v24, 0
  v_mov_b32 v25, 0
  v_mov_b32 v26, 0
  v_mov_b32 v27, 0
  v_mov_b32 v28, 0
  v_mov_b32 v29, 0
  v_mov_b32 v30, 0
  v_mov_b32 v31, 0
  v_mov_b32 v32, 0
  v_mov_b32 v33, 0
  v_mov_b32 v34, 0
  v_mov_b32 v35, 0
  v_mov_b32 v64, s49
  v_mov_b32 v65, s49
  v_mov_b32 v66, s49
  v_mov_b32 v67, s49
  s_waitcnt vmcnt(10)
  s_barrier
g1_ploop:
  ds_read_b64_tr_b16 v[48:49], v10 offset:0
  ds_read_b64_tr_b16 v[50:51], v10 offset:4096
  ds_read_b64_tr_b16 v[52:53], v10 offset:8192
  ds_read_b64_tr_b16 v[54:55], v10 offset:12288
  ds_read_b64_tr_b16 v[56:57], v11 offset:0
  ds_read_b64_tr_b16 v[58:59], v11 offset:4096
  ds_read_b64_tr_b16 v[60:61], v11 offset:8192
  ds_read_b64_tr_b16 v[62:63], v11 offset:12288
  s_cmp_eq_u32 s52, 81920
  s_cselect_b32 s53, s66, 40960
  s_add_u32 s52, s52, s53
  v_add_u32 v10, s53, v10
  v_add_u32 v11, s53, v11
  s_cmp_lt_u32 s50, 8
  s_cbranch_scc0 g1_nodma
  s_add_u32 m0, s46, s48
  s_add_u32 s5, s44, 34816
  buffer_load_dwordx4 v14, s[36:39], s44 offen lds
  s_add_u32 m0, m0, 1024
  s_nop 0
  buffer_load_dwordx4 v15, s[36:39], s44 offen lds
  s_waitcnt lgkmcnt(0)
  v_mfma_f32_16x16x32_bf16 v[20:23], v[64:67], v[48:51], v[20:23]
  s_add_u32 m0, m0, 1024
  s_add_u32 s44, s44, 278528
  buffer_load_dwordx4 v14, s[36:39], s5 offen lds
  v_mfma_f32_16x16x32_bf16 v[24:27], v[48:51], v[48:51], v[24:27]
  s_add_u32 m0, m0, 1024
  s_nop 0
  buffer_load_dwordx4 v15, s[36:39], s5 offen lds
  v_mfma_f32_16x16x32_bf16 v[28:31], v[64:67], v[56:59], v[28:31]
  s_add_u32 m0, s47, s48
  s_nop 0
  buffer_load_dwordx4 v16, s[40:43], s45 offen lds
  v_mfma_f32_16x16x32_bf16 v[32:35], v[56:59], v[56:59], v[32:35]
  s_add_u32 m0, m0, 1024
  s_nop 0
  buffer_load_dwordx4 v17, s[40:43], s45 offen lds
  v_mfma_f32_16x16x32_bf16 v[20:23], v[64:67], v[52:55], v[20:23]
  s_add_u32 m0, m0, 1024
  s_nop 0
  buffer_load_dwordx4 v18, s[40:43], s45 offen lds
  v_mfma_f32_16x16x32_bf16 v[24:27], v[52:55], v[52:55], v[24:27]
  s_add_u32 m0, m0, 10240
  s_nop 0
  buffer_load_dwordx4 v16, s[20:23], s45 offen lds
  v_mfma_f32_16x16x32_bf16 v[28:31], v[64:67], v[60:63], v[28:31]
  s_add_u32 m0, m0, 1024
  s_nop 0
  buffer_load_dwordx4 v17, s[20:23], s45 offen lds
  v_mfma_f32_16x16x32_bf16 v[32:35], v[60:63], v[60:63], v[32:35]
  s_add_u32 m0, m0, 1024
  s_nop 0
  buffer_load_dwordx4 v18, s[20:23], s45 offen lds
  s_add_u32 s45, s45, 196608
  s_cmp_eq_u32 s48, 81920
  s_cselect_b32 s51, s66, 40960
  s_add_u32 s48, s48, s51
  s_branch g1_dd
g1_nodma:
  s_waitcnt lgkmcnt(0)
  v_mfma_f32_16x16x32_bf16 v[20:23], v[64:67], v[48:51], v[20:23]
  v_mfma_f32_16x16x32_bf16 v[24:27], v[48:51], v[48:51], v[24:27]
  v_mfma_f32_16x16x32_bf16 v[28:31], v[64:67], v[56:59], v[28:31]
  v_mfma_f32_16x16x32_bf16 v[32:35], v[56:59], v[56:59], v[32:35]
  v_mfma_f32_16x16x32_bf16 v[20:23], v[64:67], v[52:55], v[20:23]
  v_mfma_f32_16x16x32_bf16 v[24:27], v[52:55], v[52:55], v[24:27]
  v_mfma_f32_16x16x32_bf16 v[28:31], v[64:67], v[60:63], v[28:31]
  v_mfma_f32_16x16x32_bf16 v[32:35], v[60:63], v[60:63], v[32:35]
g1_dd:
  s_waitcnt vmcnt(10)
  s_cmp_lt_u32 s50, 8
  s_cbranch_scc1 g1_w
  s_waitcnt vmcnt(0)
g1_w:
  s_add_u32 s50, s50, 1
  s_cmp_lt_u32 s50, 10
  s_cbranch_scc0 g1_pend
  s_barrier
  s_branch g1_ploop
g1_pend:
  s_lshl_b32 s6, s9, 9
  s_add_u32 s6, s6, 122880
  v_lshl_add_u32 v7, v6, 4, s6
  v_mov_b32 v8, 124928
  v_cmp_eq_u32 vcc, v3, v4
  s_nop 1
  v_cndmask_b32 v7, v8, v7, vcc
  v_cmp_eq_u32 vcc, 1, v5
  s_nop 1
  v_cndmask_b32 v24, v24, v25, vcc
  v_cndmask_b32 v32, v32, v33, vcc
  v_cmp_eq_u32 vcc, 2, v5
  s_nop 1
  v_cndmask_b32 v24, v24, v26, vcc
  v_cndmask_b32 v32, v32, v34, vcc
  v_cmp_eq_u32 vcc, 3, v5
  s_nop 1
  v_cndmask_b32 v24, v24, v27, vcc
  v_cndmask_b32 v32, v32, v35, vcc
  v_mul_f32 v20, 0x3acccccd, v20
  v_mul_f32 v28, 0x3acccccd, v28
  v_mul_f32 v24, 0x3acccccd, v24
  v_mul_f32 v32, 0x3acccccd, v32
  v_fma_f32 v24, -v20, v20, v24
  v_fma_f32 v32, -v28, v28, v32
  v_cvt_pk_bf16_f32 v20, v20, v24
  v_cvt_pk_bf16_f32 v28, v28, v32
  v_lshlrev_b32 v40, 16, v20
  v_lshlrev_b32 v44, 16, v28
  v_and_b32 v21, 0xffff0000, v20
  v_and_b32 v29, 0xffff0000, v28
  v_max_f32 v21, 0, v21
  v_max_f32 v29, 0, v29
  v_add_f32 v21, 0x3727c5ac, v21
  v_add_f32 v29, 0x3727c5ac, v29
  v_cvt_pk_bf16_f32 v21, v21, v21
  v_cvt_pk_bf16_f32 v29, v29, v29
  v_lshlrev_b32 v21, 16, v21
  v_lshlrev_b32 v29, 16, v29
  v_sqrt_f32 v21, v21
  v_sqrt_f32 v29, v29
  s_nop 0
  s_nop 0
  v_cvt_pk_bf16_f32 v21, v21, v21
  v_cvt_pk_bf16_f32 v29, v29, v29
  v_lshlrev_b32 v21, 16, v21
  v_lshlrev_b32 v29, 16, v29
  v_mul_f32 v43, v21, v21
  v_mul_f32 v47, v29, v29
  v_rcp_f32 v21, v21
  v_rcp_f32 v29, v29
  s_nop 0
  s_nop 0
  v_mul_f32 v41, 0xc0135761, v21
  v_mul_f32 v45, 0xc0135761, v29
  v_mul_f32 v42, v21, v21
  v_mul_f32 v46, v29, v29
  v_mul_f32 v42, v42, v21
  v_mul_f32 v46, v46, v29
  v_mul_f32 v42, 0xbdd2d3e8, v42
  v_mul_f32 v46, 0xbdd2d3e8, v46
  ds_write_b128 v7, v[40:43]
  ds_write_b128 v7, v[44:47] offset:256
  s_waitcnt lgkmcnt(0)
  s_barrier
  s_endpgm
g1_cons:
  s_and_b32 s9, s8, 1
  s_lshr_b32 s10, s8, 1
  s_waitcnt lgkmcnt(0)
  s_mov_b32 s36, s16
  s_and_b32 s37, s17, 0xffff
  s_mov_b32 s38, 268435456
  s_mov_b32 s39, 0x00020000
  s_mul_i32 s5, s10, 192
  s_lshl_b32 s6, s6, 1
  s_add_u32 s5, s5, s6
  s_add_u32 s5, s5, 17842176
  s_add_u32 s6, s5, 6144
  v_lshlrev_b32 v7, 4, v3
  buffer_load_dwordx4 v[24:27], v7, s[36:39], s5 offen offset:0
  buffer_load_dwordx4 v[36:39], v7, s[36:39], s6 offen offset:0
  buffer_load_dwordx4 v[28:31], v7, s[36:39], s5 offen offset:64
  buffer_load_dwordx4 v[40:43], v7, s[36:39], s6 offen offset:64
  buffer_load_dwordx4 v[32:35], v7, s[36:39], s5 offen offset:128
  buffer_load_dwordx4 v[44:47], v7, s[36:39], s6 offen offset:128
  s_add_u32 s5, s5, 12288
  s_add_u32 s6, s6, 12288
  buffer_load_dwordx4 v[88:91], v7, s[36:39], s5 offen offset:0
  buffer_load_dwordx4 v[100:103], v7, s[36:39], s6 offen offset:0
  buffer_load_dwordx4 v[92:95], v7, s[36:39], s5 offen offset:64
  buffer_load_dwordx4 v[104:107], v7, s[36:39], s6 offen offset:64
  buffer_load_dwordx4 v[96:99], v7, s[36:39], s5 offen offset:128
  buffer_load_dwordx4 v[108:111], v7, s[36:39], s6 offen offset:128
  v_lshl_add_u32 v7, v3, 2, v4
  v_and_b32 v8, 7, v7
  s_lshl_b32 s5, s9, 2
  v_xor_b32 v8, s5, v8
  v_lshlrev_b32 v9, 3, v5
  v_lshl_add_u32 v10, v7, 8, v9
  v_lshl_add_u32 v10, v8, 5, v10
  v_xor_b32 v11, 32, v10
  v_xor_b32 v12, 64, v10
  v_xor_b32 v13, 96, v10
  s_movk_i32 s6, 192
  v_mad_u32_u24 v9, v7, s6, v9
  v_add_u32 v9, 16384, v9
  v_and_b32 v8, 1, v3
  s_mul_i32 s6, s10, 3
  s_add_u32 s7, s6, 0
  v_xor_b32 v7, s7, v8
  v_lshl_add_u32 v14, v7, 5, v9
  s_add_u32 s7, s6, 1
  v_xor_b32 v7, s7, v8
  v_lshl_add_u32 v15, v7, 5, v9
  s_add_u32 s7, s6, 2
  v_xor_b32 v7, s7, v8
  v_lshl_add_u32 v16, v7, 5, v9
  v_mov_b32 v128, 0
  v_mov_b32 v129, 0
  v_mov_b32 v130, 0
  v_mov_b32 v131, 0
  v_mov_b32 v132, 0
  v_mov_b32 v133, 0
  v_mov_b32 v134, 0
  v_mov_b32 v135, 0
  v_mov_b32 v136, 0
  v_mov_b32 v137, 0
  v_mov_b32 v138, 0
  v_mov_b32 v139, 0
  v_mov_b32 v140, 0
  v_mov_b32 v141, 0
  v_mov_b32 v142, 0
  v_mov_b32 v143, 0
  v_mov_b32 v144, 0
  v_mov_b32 v145, 0
  v_mov_b32 v146, 0
  v_mov_b32 v147, 0
  v_mov_b32 v148, 0
  v_mov_b32 v149, 0
  v_mov_b32 v150, 0
  v_mov_b32 v151, 0
  v_mov_b32 v152, 0
  v_mov_b32 v153, 0
  v_mov_b32 v154, 0
  v_mov_b32 v155, 0
  v_mov_b32 v156, 0
  v_mov_b32 v157, 0
  v_mov_b32 v158, 0
  v_mov_b32 v159, 0
  v_mov_b32 v160, 0
  v_mov_b32 v161, 0
  v_mov_b32 v162, 0
  v_mov_b32 v163, 0
  v_mov_b32 v164, 0
  v_mov_b32 v165, 0
  v_mov_b32 v166, 0
  v_mov_b32 v167, 0
  v_mov_b32 v168, 0
  v_mov_b32 v169, 0
  v_mov_b32 v170, 0
  v_mov_b32 v171, 0
  v_mov_b32 v172, 0
  v_mov_b32 v173, 0
  v_mov_b32 v174, 0
  v_mov_b32 v175, 0
  v_mov_b32 v176, 0
  v_mov_b32 v177, 0
  v_mov_b32 v178, 0
  v_mov_b32 v179, 0
  v_mov_b32 v180, 0
  v_mov_b32 v181, 0
  v_mov_b32 v182, 0
  v_mov_b32 v183, 0
  v_mov_b32 v184, 0
  v_mov_b32 v185, 0
  v_mov_b32 v186, 0
  v_mov_b32 v187, 0
  v_mov_b32 v188, 0
  v_mov_b32 v189, 0
  v_mov_b32 v190, 0
  v_mov_b32 v191, 0
  v_mov_b32 v192, 0
  v_mov_b32 v193, 0
  v_mov_b32 v194, 0
  v_mov_b32 v195, 0
  v_mov_b32 v196, 0
  v_mov_b32 v197, 0
  v_mov_b32 v198, 0
  v_mov_b32 v199, 0
  v_mov_b32 v200, 0
  v_mov_b32 v201, 0
  v_mov_b32 v202, 0
  v_mov_b32 v203, 0
  v_mov_b32 v204, 0
  v_mov_b32 v205, 0
  v_mov_b32 v206, 0
  v_mov_b32 v207, 0
  v_mov_b32 v208, 0
  v_mov_b32 v209, 0
  v_mov_b32 v210, 0
  v_mov_b32 v211, 0
  v_mov_b32 v212, 0
  v_mov_b32 v213, 0
  v_mov_b32 v214, 0
  v_mov_b32 v215, 0
  v_mov_b32 v216, 0
  v_mov_b32 v217, 0
  v_mov_b32 v218, 0
  v_mov_b32 v219, 0
  v_mov_b32 v220, 0
  v_mov_b32 v221, 0
  v_mov_b32 v222, 0
  v_mov_b32 v223, 0
  s_lshl_b32 s6, s5, 8
  s_add_u32 s6, s6, 122880
  v_lshl_add_u32 v7, v6, 4, s6
  s_lshl_b32 s6, s3, 3
  s_add_u32 s6, s6, s5
  s_mul_i32 s7, s4, 6
  s_mul_i32 s11, s10, 3
  s_add_u32 s7, s7, s11
  v_lshlrev_b32 v9, 4, v2
  s_mul_i32 s11, s6, 50176
  s_add_u32 s11, s11, 10485760
  s_add_u32 s52, s7, 0
  s_lshr_b32 s18, s52, 1
  s_lshl_b32 s18, s18, 10
  s_and_b32 s52, s52, 1
  s_lshl_b32 s52, s52, 3
  s_add_u32 s52, s52, s18
  s_add_u32 s52, s52, s11
  s_add_u32 s55, s52, 50176
  s_add_u32 s58, s52, 100352
  s_add_u32 s61, s52, 150528
  s_add_u32 s53, s7, 1
  s_lshr_b32 s18, s53, 1
  s_lshl_b32 s18, s18, 10
  s_and_b32 s53, s53, 1
  s_lshl_b32 s53, s53, 3
  s_add_u32 s53, s53, s18
  s_add_u32 s53, s53, s11
  s_add_u32 s56, s53, 50176
  s_add_u32 s59, s53, 100352
  s_add_u32 s62, s53, 150528
  s_add_u32 s54, s7, 2
  s_lshr_b32 s18, s54, 1
  s_lshl_b32 s18, s18, 10
  s_and_b32 s54, s54, 1
  s_lshl_b32 s54, s54, 3
  s_add_u32 s54, s54, s18
  s_add_u32 s54, s54, s11
  s_add_u32 s57, s54, 50176
  s_add_u32 s60, s54, 100352
  s_add_u32 s63, s54, 150528
  s_waitcnt vmcnt(0)
  v_add_f32 v24, v24, v88
  v_add_f32 v25, v25, v89
  v_add_f32 v26, v26, v90
  v_add_f32 v27, v27, v91
  v_add_f32 v28, v28, v92
  v_add_f32 v29, v29, v93
  v_add_f32 v30, v30, v94
  v_add_f32 v31, v31, v95
  v_add_f32 v32, v32, v96
  v_add_f32 v33, v33, v97
  v_add_f32 v34, v34, v98
  v_add_f32 v35, v35, v99
  v_add_f32 v36, v36, v100
  v_add_f32 v37, v37, v101
  v_add_f32 v38, v38, v102
  v_add_f32 v39, v39, v103
  v_add_f32 v40, v40, v104
  v_add_f32 v41, v41, v105
  v_add_f32 v42, v42, v106
  v_add_f32 v43, v43, v107
  v_add_f32 v44, v44, v108
  v_add_f32 v45, v45, v109
  v_add_f32 v46, v46, v110
  v_add_f32 v47, v47, v111
  s_barrier
  ds_read_b64_tr_b16 v[48:49], v10 offset:0
  ds_read_b64_tr_b16 v[50:51], v10 offset:4096
  ds_read_b64_tr_b16 v[52:53], v11 offset:0
  ds_read_b64_tr_b16 v[54:55], v11 offset:4096
  ds_read_b64_tr_b16 v[56:57], v12 offset:0
  ds_read_b64_tr_b16 v[58:59], v12 offset:4096
  ds_read_b64_tr_b16 v[60:61], v13 offset:0
  ds_read_b64_tr_b16 v[62:63], v13 offset:4096
  ds_read_b64_tr_b16 v[64:65], v14 offset:0
  ds_read_b64_tr_b16 v[66:67], v14 offset:3072
  ds_read_b64_tr_b16 v[68:69], v14 offset:12288
  ds_read_b64_tr_b16 v[70:71], v14 offset:15360
  ds_read_b64_tr_b16 v[72:73], v15 offset:0
  ds_read_b64_tr_b16 v[74:75], v15 offset:3072
  ds_read_b64_tr_b16 v[76:77], v15 offset:12288
  ds_read_b64_tr_b16 v[78:79], v15 offset:15360
  ds_read_b64_tr_b16 v[80:81], v16 offset:0
  ds_read_b64_tr_b16 v[82:83], v16 offset:3072
  ds_read_b64_tr_b16 v[84:85], v16 offset:12288
  ds_read_b64_tr_b16 v[86:87], v16 offset:15360
g1_loop:
  s_waitcnt lgkmcnt(0)
  v_mfma_f32_16x16x32_bf16 v[128:131], v[64:67], v[48:51], v[128:131]
  ds_read_b64_tr_b16 v[88:89], v10 offset:8192
  ds_read_b64_tr_b16 v[90:91], v10 offset:12288
  v_mfma_f32_16x16x32_bf16 v[132:135], v[64:67], v[52:55], v[132:135]
  ds_read_b64_tr_b16 v[92:93], v11 offset:8192
  ds_read_b64_tr_b16 v[94:95], v11 offset:12288
  v_mfma_f32_16x16x32_bf16 v[136:139], v[64:67], v[56:59], v[136:139]
  ds_read_b64_tr_b16 v[96:97], v12 offset:8192
  ds_read_b64_tr_b16 v[98:99], v12 offset:12288
  v_mfma_f32_16x16x32_bf16 v[140:143], v[64:67], v[60:63], v[140:143]
  ds_read_b64_tr_b16 v[100:101], v13 offset:8192
  ds_read_b64_tr_b16 v[102:103], v13 offset:12288
  v_mfma_f32_16x16x32_bf16 v[144:147], v[68:71], v[48:51], v[144:147]
  ds_read_b64_tr_b16 v[104:105], v14 offset:6144
  ds_read_b64_tr_b16 v[106:107], v14 offset:9216
  v_mfma_f32_16x16x32_bf16 v[148:151], v[68:71], v[52:55], v[148:151]
  ds_read_b64_tr_b16 v[108:109], v14 offset:18432
  ds_read_b64_tr_b16 v[110:111], v14 offset:21504
  v_mfma_f32_16x16x32_bf16 v[152:155], v[68:71], v[56:59], v[152:155]
  ds_read_b64_tr_b16 v[112:113], v15 offset:6144
  ds_read_b64_tr_b16 v[114:115], v15 offset:9216
  v_mfma_f32_16x16x32_bf16 v[156:159], v[68:71], v[60:63], v[156:159]
  ds_read_b64_tr_b16 v[116:117], v15 offset:18432
  ds_read_b64_tr_b16 v[118:119], v15 offset:21504
  v_mfma_f32_16x16x32_bf16 v[160:163], v[72:75], v[48:51], v[160:163]
  ds_read_b64_tr_b16 v[120:121], v16 offset:6144
  ds_read_b64_tr_b16 v[122:123], v16 offset:9216
  v_mfma_f32_16x16x32_bf16 v[164:167], v[72:75], v[52:55], v[164:167]
  ds_read_b64_tr_b16 v[124:125], v16 offset:18432
  ds_read_b64_tr_b16 v[126:127], v16 offset:21504
  v_mfma_f32_16x16x32_bf16 v[168:171], v[72:75], v[56:59], v[168:171]
  s_cmp_eq_u32 s48, 81920
  v_mfma_f32_16x16x32_bf16 v[172:175], v[72:75], v[60:63], v[172:175]
  s_cselect_b32 s51, s66, 40960
  v_mfma_f32_16x16x32_bf16 v[176:179], v[76:79], v[48:51], v[176:179]
  s_add_u32 s48, s48, s51
  v_mfma_f32_16x16x32_bf16 v[180:183], v[76:79], v[52:55], v[180:183]
  v_add_u32 v10, s51, v10
  v_mfma_f32_16x16x32_bf16 v[184:187], v[76:79], v[56:59], v[184:187]
  v_add_u32 v11, s51, v11
  v_mfma_f32_16x16x32_bf16 v[188:191], v[76:79], v[60:63], v[188:191]
  v_add_u32 v12, s51, v12
  v_mfma_f32_16x16x32_bf16 v[192:195], v[80:83], v[48:51], v[192:195]
  v_add_u32 v13, s51, v13
  v_mfma_f32_16x16x32_bf16 v[196:199], v[80:83], v[52:55], v[196:199]
  v_add_u32 v14, s51, v14
  v_mfma_f32_16x16x32_bf16 v[200:203], v[80:83], v[56:59], v[200:203]
  v_add_u32 v15, s51, v15
  v_mfma_f32_16x16x32_bf16 v[204:207], v[80:83], v[60:63], v[204:207]
  v_add_u32 v16, s51, v16
  v_mfma_f32_16x16x32_bf16 v[208:211], v[84:87], v[48:51], v[208:211]
  v_mfma_f32_16x16x32_bf16 v[212:215], v[84:87], v[52:55], v[212:215]
  v_mfma_f32_16x16x32_bf16 v[216:219], v[84:87], v[56:59], v[216:219]
  v_mfma_f32_16x16x32_bf16 v[220:223], v[84:87], v[60:63], v[220:223]
  s_waitcnt lgkmcnt(0)
  s_barrier
  v_mfma_f32_16x16x32_bf16 v[128:131], v[104:107], v[88:91], v[128:131]
  ds_read_b64_tr_b16 v[48:49], v10 offset:0
  ds_read_b64_tr_b16 v[50:51], v10 offset:4096
  v_mfma_f32_16x16x32_bf16 v[132:135], v[104:107], v[92:95], v[132:135]
  ds_read_b64_tr_b16 v[52:53], v11 offset:0
  ds_read_b64_tr_b16 v[54:55], v11 offset:4096
  v_mfma_f32_16x16x32_bf16 v[136:139], v[104:107], v[96:99], v[136:139]
  ds_read_b64_tr_b16 v[56:57], v12 offset:0
  ds_read_b64_tr_b16 v[58:59], v12 offset:4096
  v_mfma_f32_16x16x32_bf16 v[140:143], v[104:107], v[100:103], v[140:143]
  ds_read_b64_tr_b16 v[60:61], v13 offset:0
  ds_read_b64_tr_b16 v[62:63], v13 offset:4096
  v_mfma_f32_16x16x32_bf16 v[144:147], v[108:111], v[88:91], v[144:147]
  ds_read_b64_tr_b16 v[64:65], v14 offset:0
  ds_read_b64_tr_b16 v[66:67], v14 offset:3072
  v_mfma_f32_16x16x32_bf16 v[148:151], v[108:111], v[92:95], v[148:151]
  ds_read_b64_tr_b16 v[68:69], v14 offset:12288
  ds_read_b64_tr_b16 v[70:71], v14 offset:15360
  v_mfma_f32_16x16x32_bf16 v[152:155], v[108:111], v[96:99], v[152:155]
  ds_read_b64_tr_b16 v[72:73], v15 offset:0
  ds_read_b64_tr_b16 v[74:75], v15 offset:3072
  v_mfma_f32_16x16x32_bf16 v[156:159], v[108:111], v[100:103], v[156:159]
  ds_read_b64_tr_b16 v[76:77], v15 offset:12288
  ds_read_b64_tr_b16 v[78:79], v15 offset:15360
  v_mfma_f32_16x16x32_bf16 v[160:163], v[112:115], v[88:91], v[160:163]
  ds_read_b64_tr_b16 v[80:81], v16 offset:0
  ds_read_b64_tr_b16 v[82:83], v16 offset:3072
  v_mfma_f32_16x16x32_bf16 v[164:167], v[112:115], v[92:95], v[164:167]
  ds_read_b64_tr_b16 v[84:85], v16 offset:12288
  ds_read_b64_tr_b16 v[86:87], v16 offset:15360
  v_mfma_f32_16x16x32_bf16 v[168:171], v[112:115], v[96:99], v[168:171]
  s_add_u32 s50, s50, 1
  v_mfma_f32_16x16x32_bf16 v[172:175], v[112:115], v[100:103], v[172:175]
  s_cmp_lt_u32 s50, 10
  v_mfma_f32_16x16x32_bf16 v[176:179], v[116:119], v[88:91], v[176:179]
  v_mfma_f32_16x16x32_bf16 v[180:183], v[116:119], v[92:95], v[180:183]
  v_mfma_f32_16x16x32_bf16 v[184:187], v[116:119], v[96:99], v[184:187]
  v_mfma_f32_16x16x32_bf16 v[188:191], v[116:119], v[100:103], v[188:191]
  v_mfma_f32_16x16x32_bf16 v[192:195], v[120:123], v[88:91], v[192:195]
  v_mfma_f32_16x16x32_bf16 v[196:199], v[120:123], v[92:95], v[196:199]
  v_mfma_f32_16x16x32_bf16 v[200:203], v[120:123], v[96:99], v[200:203]
  v_mfma_f32_16x16x32_bf16 v[204:207], v[120:123], v[100:103], v[204:207]
  v_mfma_f32_16x16x32_bf16 v[208:211], v[124:127], v[88:91], v[208:211]
  v_mfma_f32_16x16x32_bf16 v[212:215], v[124:127], v[92:95], v[212:215]
  v_mfma_f32_16x16x32_bf16 v[216:219], v[124:127], v[96:99], v[216:219]
  v_mfma_f32_16x16x32_bf16 v[220:223], v[124:127], v[100:103], v[220:223]
  s_cbranch_scc1 g1_loop
  s_waitcnt lgkmcnt(0)
  ds_read_b128 v[48:51], v7 offset:0
  ds_read_b128 v[56:59], v7 offset:256
  ds_read_b128 v[64:67], v7 offset:512
  ds_read_b128 v[72:75], v7 offset:768
  s_waitcnt lgkmcnt(0)
  s_waitcnt vmcnt(0)
  v_pk_fma_f32 v[128:129], v[24:25], v[48:49], v[128:129] op_sel_hi:[1,0,1] neg_lo:[0,1,0] neg_hi:[0,1,0]
  v_pk_fma_f32 v[130:131], v[26:27], v[48:49], v[130:131] op_sel_hi:[1,0,1] neg_lo:[0,1,0] neg_hi:[0,1,0]
  v_pk_fma_f32 v[132:133], v[24:25], v[56:57], v[132:133] op_sel_hi:[1,0,1] neg_lo:[0,1,0] neg_hi:[0,1,0]
  v_pk_fma_f32 v[134:135], v[26:27], v[56:57], v[134:135] op_sel_hi:[1,0,1] neg_lo:[0,1,0] neg_hi:[0,1,0]
  v_pk_fma_f32 v[136:137], v[24:25], v[64:65], v[136:137] op_sel_hi:[1,0,1] neg_lo:[0,1,0] neg_hi:[0,1,0]
  v_pk_fma_f32 v[138:139], v[26:27], v[64:65], v[138:139] op_sel_hi:[1,0,1] neg_lo:[0,1,0] neg_hi:[0,1,0]
  v_pk_fma_f32 v[140:141], v[24:25], v[72:73], v[140:141] op_sel_hi:[1,0,1] neg_lo:[0,1,0] neg_hi:[0,1,0]
  v_pk_fma_f32 v[142:143], v[26:27], v[72:73], v[142:143] op_sel_hi:[1,0,1] neg_lo:[0,1,0] neg_hi:[0,1,0]
  v_pk_mul_f32 v[80:81], v[128:129], v[128:129]
  v_pk_mul_f32 v[82:83], v[130:131], v[130:131]
  v_pk_mul_f32 v[84:85], v[132:133], v[132:133]
  v_pk_mul_f32 v[86:87], v[134:135], v[134:135]
  v_pk_mul_f32 v[88:89], v[136:137], v[136:137]
  v_pk_mul_f32 v[90:91], v[138:139], v[138:139]
  v_pk_mul_f32 v[92:93], v[140:141], v[140:141]
  v_pk_mul_f32 v[94:95], v[142:143], v[142:143]
  v_pk_fma_f32 v[80:81], v[80:81], v[50:51], v[48:49] op_sel:[0,0,1] op_sel_hi:[1,0,1]
  v_pk_fma_f32 v[82:83], v[82:83], v[50:51], v[48:49] op_sel:[0,0,1] op_sel_hi:[1,0,1]
  v_pk_fma_f32 v[84:85], v[84:85], v[58:59], v[56:57] op_sel:[0,0,1] op_sel_hi:[1,0,1]
  v_pk_fma_f32 v[86:87], v[86:87], v[58:59], v[56:57] op_sel:[0,0,1] op_sel_hi:[1,0,1]
  v_pk_fma_f32 v[88:89], v[88:89], v[66:67], v[64:65] op_sel:[0,0,1] op_sel_hi:[1,0,1]
  v_pk_fma_f32 v[90:91], v[90:91], v[66:67], v[64:65] op_sel:[0,0,1] op_sel_hi:[1,0,1]
  v_pk_fma_f32 v[92:93], v[92:93], v[74:75], v[72:73] op_sel:[0,0,1] op_sel_hi:[1,0,1]
  v_pk_fma_f32 v[94:95], v[94:95], v[74:75], v[72:73] op_sel:[0,0,1] op_sel_hi:[1,0,1]
  v_pk_mul_f32 v[80:81], v[80:81], v[128:129]
  v_pk_mul_f32 v[82:83], v[82:83], v[130:131]
  v_pk_mul_f32 v[84:85], v[84:85], v[132:133]
  v_pk_mul_f32 v[86:87], v[86:87], v[134:135]
  v_pk_mul_f32 v[88:89], v[88:89], v[136:137]
  v_pk_mul_f32 v[90:91], v[90:91], v[138:139]
  v_pk_mul_f32 v[92:93], v[92:93], v[140:141]
  v_pk_mul_f32 v[94:95], v[94:95], v[142:143]
  v_exp_f32 v80, v80
  v_pk_fma_f32 v[160:161], v[28:29], v[48:49], v[160:161] op_sel_hi:[1,0,1] neg_lo:[0,1,0] neg_hi:[0,1,0]
  v_exp_f32 v81, v81
  v_pk_fma_f32 v[162:163], v[30:31], v[48:49], v[162:163] op_sel_hi:[1,0,1] neg_lo:[0,1,0] neg_hi:[0,1,0]
  v_pk_fma_f32 v[144:145], v[36:37], v[48:49], v[144:145] op_sel_hi:[1,0,1] neg_lo:[0,1,0] neg_hi:[0,1,0]
  v_pk_fma_f32 v[164:165], v[28:29], v[56:57], v[164:165] op_sel_hi:[1,0,1] neg_lo:[0,1,0] neg_hi:[0,1,0]
  v_exp_f32 v82, v82
  v_pk_fma_f32 v[166:167], v[30:31], v[56:57], v[166:167] op_sel_hi:[1,0,1] neg_lo:[0,1,0] neg_hi:[0,1,0]
  v_exp_f32 v83, v83
  v_pk_fma_f32 v[168:169], v[28:29], v[64:65], v[168:169] op_sel_hi:[1,0,1] neg_lo:[0,1,0] neg_hi:[0,1,0]
  v_pk_fma_f32 v[146:147], v[38:39], v[48:49], v[146:147] op_sel_hi:[1,0,1] neg_lo:[0,1,0] neg_hi:[0,1,0]
  v_pk_fma_f32 v[170:171], v[30:31], v[64:65], v[170:171] op_sel_hi:[1,0,1] neg_lo:[0,1,0] neg_hi:[0,1,0]
  v_exp_f32 v84, v84
  v_pk_fma_f32 v[172:173], v[28:29], v[72:73], v[172:173] op_sel_hi:[1,0,1] neg_lo:[0,1,0] neg_hi:[0,1,0]
  v_exp_f32 v85, v85
  v_pk_fma_f32 v[174:175], v[30:31], v[72:73], v[174:175] op_sel_hi:[1,0,1] neg_lo:[0,1,0] neg_hi:[0,1,0]
  v_pk_fma_f32 v[148:149], v[36:37], v[56:57], v[148:149] op_sel_hi:[1,0,1] neg_lo:[0,1,0] neg_hi:[0,1,0]
  v_pk_mul_f32 v[96:97], v[160:161], v[160:161]
  v_exp_f32 v86, v86
  v_pk_mul_f32 v[98:99], v[162:163], v[162:163]
  v_exp_f32 v87, v87
  v_pk_mul_f32 v[100:101], v[164:165], v[164:165]
  v_pk_fma_f32 v[150:151], v[38:39], v[56:57], v[150:151] op_sel_hi:[1,0,1] neg_lo:[0,1,0] neg_hi:[0,1,0]
  v_pk_mul_f32 v[102:103], v[166:167], v[166:167]
  v_exp_f32 v88, v88
  v_pk_mul_f32 v[104:105], v[168:169], v[168:169]
  v_exp_f32 v89, v89
  v_pk_mul_f32 v[106:107], v[170:171], v[170:171]
  v_pk_fma_f32 v[152:153], v[36:37], v[64:65], v[152:153] op_sel_hi:[1,0,1] neg_lo:[0,1,0] neg_hi:[0,1,0]
  v_pk_mul_f32 v[108:109], v[172:173], v[172:173]
  v_exp_f32 v90, v90
  v_pk_mul_f32 v[110:111], v[174:175], v[174:175]
  v_exp_f32 v91, v91
  v_pk_fma_f32 v[96:97], v[96:97], v[50:51], v[48:49] op_sel:[0,0,1] op_sel_hi:[1,0,1]
  v_pk_fma_f32 v[154:155], v[38:39], v[64:65], v[154:155] op_sel_hi:[1,0,1] neg_lo:[0,1,0] neg_hi:[0,1,0]
  v_pk_fma_f32 v[98:99], v[98:99], v[50:51], v[48:49] op_sel:[0,0,1] op_sel_hi:[1,0,1]
  v_exp_f32 v92, v92
  v_pk_fma_f32 v[100:101], v[100:101], v[58:59], v[56:57] op_sel:[0,0,1] op_sel_hi:[1,0,1]
  v_exp_f32 v93, v93
  v_pk_fma_f32 v[102:103], v[102:103], v[58:59], v[56:57] op_sel:[0,0,1] op_sel_hi:[1,0,1]
  v_pk_fma_f32 v[156:157], v[36:37], v[72:73], v[156:157] op_sel_hi:[1,0,1] neg_lo:[0,1,0] neg_hi:[0,1,0]
  v_pk_fma_f32 v[104:105], v[104:105], v[66:67], v[64:65] op_sel:[0,0,1] op_sel_hi:[1,0,1]
  v_exp_f32 v94, v94
  v_pk_fma_f32 v[106:107], v[106:107], v[66:67], v[64:65] op_sel:[0,0,1] op_sel_hi:[1,0,1]
  v_exp_f32 v95, v95
  v_pk_fma_f32 v[108:109], v[108:109], v[74:75], v[72:73] op_sel:[0,0,1] op_sel_hi:[1,0,1]
  v_pk_fma_f32 v[158:159], v[38:39], v[72:73], v[158:159] op_sel_hi:[1,0,1] neg_lo:[0,1,0] neg_hi:[0,1,0]
  v_pk_fma_f32 v[110:111], v[110:111], v[74:75], v[72:73] op_sel:[0,0,1] op_sel_hi:[1,0,1]
  v_pk_fma_f32 v[80:81], v[80:81], v[50:51], v[50:51] op_sel:[0,1,1] op_sel_hi:[1,1,1]
  v_pk_mul_f32 v[96:97], v[96:97], v[160:161]
  v_pk_fma_f32 v[82:83], v[82:83], v[50:51], v[50:51] op_sel:[0,1,1] op_sel_hi:[1,1,1]
  v_pk_mul_f32 v[98:99], v[98:99], v[162:163]
  v_pk_fma_f32 v[84:85], v[84:85], v[58:59], v[58:59] op_sel:[0,1,1] op_sel_hi:[1,1,1]
  v_pk_mul_f32 v[100:101], v[100:101], v[164:165]
  v_pk_fma_f32 v[86:87], v[86:87], v[58:59], v[58:59] op_sel:[0,1,1] op_sel_hi:[1,1,1]
  v_pk_mul_f32 v[102:103], v[102:103], v[166:167]
  v_pk_fma_f32 v[88:89], v[88:89], v[66:67], v[66:67] op_sel:[0,1,1] op_sel_hi:[1,1,1]
  v_pk_mul_f32 v[104:105], v[104:105], v[168:169]
  v_pk_fma_f32 v[90:91], v[90:91], v[66:67], v[66:67] op_sel:[0,1,1] op_sel_hi:[1,1,1]
  v_pk_mul_f32 v[106:107], v[106:107], v[170:171]
  v_pk_fma_f32 v[92:93], v[92:93], v[74:75], v[74:75] op_sel:[0,1,1] op_sel_hi:[1,1,1]
  v_pk_mul_f32 v[108:109], v[108:109], v[172:173]
  v_pk_fma_f32 v[94:95], v[94:95], v[74:75], v[74:75] op_sel:[0,1,1] op_sel_hi:[1,1,1]
  v_pk_mul_f32 v[110:111], v[110:111], v[174:175]
  v_rcp_f32 v80, v80
  v_exp_f32 v96, v96
  v_pk_fma_f32 v[192:193], v[32:33], v[48:49], v[192:193] op_sel_hi:[1,0,1] neg_lo:[0,1,0] neg_hi:[0,1,0]
  v_rcp_f32 v81, v81
  v_exp_f32 v97, v97
  v_pk_fma_f32 v[194:195], v[34:35], v[48:49], v[194:195] op_sel_hi:[1,0,1] neg_lo:[0,1,0] neg_hi:[0,1,0]
  v_pk_mul_f32 v[144:145], v[144:145], v[128:129]
  v_pk_fma_f32 v[176:177], v[40:41], v[48:49], v[176:177] op_sel_hi:[1,0,1] neg_lo:[0,1,0] neg_hi:[0,1,0]
  v_pk_fma_f32 v[196:197], v[32:33], v[56:57], v[196:197] op_sel_hi:[1,0,1] neg_lo:[0,1,0] neg_hi:[0,1,0]
  v_rcp_f32 v82, v82
  v_exp_f32 v98, v98
  v_pk_fma_f32 v[198:199], v[34:35], v[56:57], v[198:199] op_sel_hi:[1,0,1] neg_lo:[0,1,0] neg_hi:[0,1,0]
  v_rcp_f32 v83, v83
  v_exp_f32 v99, v99
  v_pk_fma_f32 v[200:201], v[32:33], v[64:65], v[200:201] op_sel_hi:[1,0,1] neg_lo:[0,1,0] neg_hi:[0,1,0]
  v_pk_mul_f32 v[146:147], v[146:147], v[130:131]
  v_pk_fma_f32 v[178:179], v[42:43], v[48:49], v[178:179] op_sel_hi:[1,0,1] neg_lo:[0,1,0] neg_hi:[0,1,0]
  v_pk_fma_f32 v[202:203], v[34:35], v[64:65], v[202:203] op_sel_hi:[1,0,1] neg_lo:[0,1,0] neg_hi:[0,1,0]
  v_rcp_f32 v84, v84
  v_exp_f32 v100, v100
  v_pk_fma_f32 v[204:205], v[32:33], v[72:73], v[204:205] op_sel_hi:[1,0,1] neg_lo:[0,1,0] neg_hi:[0,1,0]
  v_rcp_f32 v85, v85
  v_exp_f32 v101, v101
  v_pk_fma_f32 v[206:207], v[34:35], v[72:73], v[206:207] op_sel_hi:[1,0,1] neg_lo:[0,1,0] neg_hi:[0,1,0]
  v_pk_mul_f32 v[148:149], v[148:149], v[132:133]
  v_pk_fma_f32 v[180:181], v[40:41], v[56:57], v[180:181] op_sel_hi:[1,0,1] neg_lo:[0,1,0] neg_hi:[0,1,0]
  v_pk_mul_f32 v[112:113], v[192:193], v[192:193]
  v_rcp_f32 v86, v86
  v_exp_f32 v102, v102
  v_pk_mul_f32 v[114:115], v[194:195], v[194:195]
  v_rcp_f32 v87, v87
  v_exp_f32 v103, v103
  v_pk_mul_f32 v[116:117], v[196:197], v[196:197]
  v_pk_mul_f32 v[150:151], v[150:151], v[134:135]
  v_pk_fma_f32 v[182:183], v[42:43], v[56:57], v[182:183] op_sel_hi:[1,0,1] neg_lo:[0,1,0] neg_hi:[0,1,0]
  v_pk_mul_f32 v[118:119], v[198:199], v[198:199]
  v_rcp_f32 v88, v88
  v_exp_f32 v104, v104
  v_pk_mul_f32 v[120:121], v[200:201], v[200:201]
  v_rcp_f32 v89, v89
  v_exp_f32 v105, v105
  v_pk_mul_f32 v[122:123], v[202:203], v[202:203]
  v_pk_mul_f32 v[152:153], v[152:153], v[136:137]
  v_pk_fma_f32 v[184:185], v[40:41], v[64:65], v[184:185] op_sel_hi:[1,0,1] neg_lo:[0,1,0] neg_hi:[0,1,0]
  v_pk_mul_f32 v[124:125], v[204:205], v[204:205]
  v_rcp_f32 v90, v90
  v_exp_f32 v106, v106
  v_pk_mul_f32 v[126:127], v[206:207], v[206:207]
  v_rcp_f32 v91, v91
  v_exp_f32 v107, v107
  v_pk_fma_f32 v[112:113], v[112:113], v[50:51], v[48:49] op_sel:[0,0,1] op_sel_hi:[1,0,1]
  v_pk_mul_f32 v[154:155], v[154:155], v[138:139]
  v_pk_fma_f32 v[186:187], v[42:43], v[64:65], v[186:187] op_sel_hi:[1,0,1] neg_lo:[0,1,0] neg_hi:[0,1,0]
  v_pk_fma_f32 v[114:115], v[114:115], v[50:51], v[48:49] op_sel:[0,0,1] op_sel_hi:[1,0,1]
  v_rcp_f32 v92, v92
  v_exp_f32 v108, v108
  v_pk_fma_f32 v[116:117], v[116:117], v[58:59], v[56:57] op_sel:[0,0,1] op_sel_hi:[1,0,1]
  v_rcp_f32 v93, v93
  v_exp_f32 v109, v109
  v_pk_fma_f32 v[118:119], v[118:119], v[58:59], v[56:57] op_sel:[0,0,1] op_sel_hi:[1,0,1]
  v_pk_mul_f32 v[156:157], v[156:157], v[140:141]
  v_pk_fma_f32 v[188:189], v[40:41], v[72:73], v[188:189] op_sel_hi:[1,0,1] neg_lo:[0,1,0] neg_hi:[0,1,0]
  v_pk_fma_f32 v[120:121], v[120:121], v[66:67], v[64:65] op_sel:[0,0,1] op_sel_hi:[1,0,1]
  v_rcp_f32 v94, v94
  v_exp_f32 v110, v110
  v_pk_fma_f32 v[122:123], v[122:123], v[66:67], v[64:65] op_sel:[0,0,1] op_sel_hi:[1,0,1]
  v_rcp_f32 v95, v95
  v_exp_f32 v111, v111
  v_pk_fma_f32 v[124:125], v[124:125], v[74:75], v[72:73] op_sel:[0,0,1] op_sel_hi:[1,0,1]
  v_pk_mul_f32 v[158:159], v[158:159], v[142:143]
  v_pk_fma_f32 v[190:191], v[42:43], v[72:73], v[190:191] op_sel_hi:[1,0,1] neg_lo:[0,1,0] neg_hi:[0,1,0]
  v_pk_fma_f32 v[126:127], v[126:127], v[74:75], v[72:73] op_sel:[0,0,1] op_sel_hi:[1,0,1]
  v_pk_mul_f32 v[144:145], v[144:145], v[80:81]
  v_pk_fma_f32 v[96:97], v[96:97], v[50:51], v[50:51] op_sel:[0,1,1] op_sel_hi:[1,1,1]
  v_pk_mul_f32 v[112:113], v[112:113], v[192:193]
  v_pk_mul_f32 v[146:147], v[146:147], v[82:83]
  v_pk_fma_f32 v[98:99], v[98:99], v[50:51], v[50:51] op_sel:[0,1,1] op_sel_hi:[1,1,1]
  v_pk_mul_f32 v[114:115], v[114:115], v[194:195]
  v_pk_mul_f32 v[148:149], v[148:149], v[84:85]
  v_pk_fma_f32 v[100:101], v[100:101], v[58:59], v[58:59] op_sel:[0,1,1] op_sel_hi:[1,1,1]
  v_pk_mul_f32 v[116:117], v[116:117], v[196:197]
  v_pk_mul_f32 v[150:151], v[150:151], v[86:87]
  v_pk_fma_f32 v[102:103], v[102:103], v[58:59], v[58:59] op_sel:[0,1,1] op_sel_hi:[1,1,1]
  v_pk_mul_f32 v[118:119], v[118:119], v[198:199]
  v_pk_mul_f32 v[152:153], v[152:153], v[88:89]
  v_pk_fma_f32 v[104:105], v[104:105], v[66:67], v[66:67] op_sel:[0,1,1] op_sel_hi:[1,1,1]
  v_pk_mul_f32 v[120:121], v[120:121], v[200:201]
  v_pk_mul_f32 v[154:155], v[154:155], v[90:91]
  v_pk_fma_f32 v[106:107], v[106:107], v[66:67], v[66:67] op_sel:[0,1,1] op_sel_hi:[1,1,1]
  v_pk_mul_f32 v[122:123], v[122:123], v[202:203]
  v_pk_mul_f32 v[156:157], v[156:157], v[92:93]
  v_pk_fma_f32 v[108:109], v[108:109], v[74:75], v[74:75] op_sel:[0,1,1] op_sel_hi:[1,1,1]
  v_pk_mul_f32 v[124:125], v[124:125], v[204:205]
  v_pk_mul_f32 v[158:159], v[158:159], v[94:95]
  v_pk_fma_f32 v[110:111], v[110:111], v[74:75], v[74:75] op_sel:[0,1,1] op_sel_hi:[1,1,1]
  v_pk_mul_f32 v[126:127], v[126:127], v[206:207]
  v_cvt_pk_bf16_f32 v128, v144, v145
  v_rcp_f32 v96, v96
  v_exp_f32 v112, v112
  v_cvt_pk_bf16_f32 v129, v146, v147
  v_rcp_f32 v97, v97
  v_exp_f32 v113, v113
  buffer_store_dwordx2 v[128:129], v9, s[36:39], s52 offen
  v_pk_mul_f32 v[176:177], v[176:177], v[160:161]
  v_pk_fma_f32 v[208:209], v[44:45], v[48:49], v[208:209] op_sel_hi:[1,0,1] neg_lo:[0,1,0] neg_hi:[0,1,0]
  v_cvt_pk_bf16_f32 v132, v148, v149
  v_rcp_f32 v98, v98
  v_exp_f32 v114, v114
  v_cvt_pk_bf16_f32 v133, v150, v151
  v_rcp_f32 v99, v99
  v_exp_f32 v115, v115
  buffer_store_dwordx2 v[132:133], v9, s[36:39], s55 offen
  v_pk_mul_f32 v[178:179], v[178:179], v[162:163]
  v_pk_fma_f32 v[210:211], v[46:47], v[48:49], v[210:211] op_sel_hi:[1,0,1] neg_lo:[0,1,0] neg_hi:[0,1,0]
  v_cvt_pk_bf16_f32 v136, v152, v153
  v_rcp_f32 v100, v100
  v_exp_f32 v116, v116
  v_cvt_pk_bf16_f32 v137, v154, v155
  v_rcp_f32 v101, v101
  v_exp_f32 v117, v117
  buffer_store_dwordx2 v[136:137], v9, s[36:39], s58 offen
  v_pk_mul_f32 v[180:181], v[180:181], v[164:165]
  v_pk_fma_f32 v[212:213], v[44:45], v[56:57], v[212:213] op_sel_hi:[1,0,1] neg_lo:[0,1,0] neg_hi:[0,1,0]
  v_cvt_pk_bf16_f32 v140, v156, v157
  v_rcp_f32 v102, v102
  v_exp_f32 v118, v118
  v_cvt_pk_bf16_f32 v141, v158, v159
  v_rcp_f32 v103, v103
  v_exp_f32 v119, v119
  buffer_store_dwordx2 v[140:141], v9, s[36:39], s61 offen
  v_pk_mul_f32 v[182:183], v[182:183], v[166:167]
  v_pk_fma_f32 v[214:215], v[46:47], v[56:57], v[214:215] op_sel_hi:[1,0,1] neg_lo:[0,1,0] neg_hi:[0,1,0]
  v_rcp_f32 v104, v104
  v_exp_f32 v120, v120
  v_rcp_f32 v105, v105
  v_exp_f32 v121, v121
  v_pk_mul_f32 v[184:185], v[184:185], v[168:169]
  v_pk_fma_f32 v[216:217], v[44:45], v[64:65], v[216:217] op_sel_hi:[1,0,1] neg_lo:[0,1,0] neg_hi:[0,1,0]
  v_rcp_f32 v106, v106
  v_exp_f32 v122, v122
  v_rcp_f32 v107, v107
  v_exp_f32 v123, v123
  v_pk_mul_f32 v[186:187], v[186:187], v[170:171]
  v_pk_fma_f32 v[218:219], v[46:47], v[64:65], v[218:219] op_sel_hi:[1,0,1] neg_lo:[0,1,0] neg_hi:[0,1,0]
  v_rcp_f32 v108, v108
  v_exp_f32 v124, v124
  v_rcp_f32 v109, v109
  v_exp_f32 v125, v125
  v_pk_mul_f32 v[188:189], v[188:189], v[172:173]
  v_pk_fma_f32 v[220:221], v[44:45], v[72:73], v[220:221] op_sel_hi:[1,0,1] neg_lo:[0,1,0] neg_hi:[0,1,0]
  v_rcp_f32 v110, v110
  v_exp_f32 v126, v126
  v_rcp_f32 v111, v111
  v_exp_f32 v127, v127
  v_pk_mul_f32 v[190:191], v[190:191], v[174:175]
  v_pk_fma_f32 v[222:223], v[46:47], v[72:73], v[222:223] op_sel_hi:[1,0,1] neg_lo:[0,1,0] neg_hi:[0,1,0]
  v_pk_mul_f32 v[176:177], v[176:177], v[96:97]
  v_pk_fma_f32 v[112:113], v[112:113], v[50:51], v[50:51] op_sel:[0,1,1] op_sel_hi:[1,1,1]
  v_pk_mul_f32 v[178:179], v[178:179], v[98:99]
  v_pk_fma_f32 v[114:115], v[114:115], v[50:51], v[50:51] op_sel:[0,1,1] op_sel_hi:[1,1,1]
  v_pk_mul_f32 v[180:181], v[180:181], v[100:101]
  v_pk_fma_f32 v[116:117], v[116:117], v[58:59], v[58:59] op_sel:[0,1,1] op_sel_hi:[1,1,1]
  v_pk_mul_f32 v[182:183], v[182:183], v[102:103]
  v_pk_fma_f32 v[118:119], v[118:119], v[58:59], v[58:59] op_sel:[0,1,1] op_sel_hi:[1,1,1]
  v_pk_mul_f32 v[184:185], v[184:185], v[104:105]
  v_pk_fma_f32 v[120:121], v[120:121], v[66:67], v[66:67] op_sel:[0,1,1] op_sel_hi:[1,1,1]
  v_pk_mul_f32 v[186:187], v[186:187], v[106:107]
  v_pk_fma_f32 v[122:123], v[122:123], v[66:67], v[66:67] op_sel:[0,1,1] op_sel_hi:[1,1,1]
  v_pk_mul_f32 v[188:189], v[188:189], v[108:109]
  v_pk_fma_f32 v[124:125], v[124:125], v[74:75], v[74:75] op_sel:[0,1,1] op_sel_hi:[1,1,1]
  v_pk_mul_f32 v[190:191], v[190:191], v[110:111]
  v_pk_fma_f32 v[126:127], v[126:127], v[74:75], v[74:75] op_sel:[0,1,1] op_sel_hi:[1,1,1]
  v_cvt_pk_bf16_f32 v160, v176, v177
  v_rcp_f32 v112, v112
  v_cvt_pk_bf16_f32 v161, v178, v179
  v_rcp_f32 v113, v113
  buffer_store_dwordx2 v[160:161], v9, s[36:39], s53 offen
  v_pk_mul_f32 v[208:209], v[208:209], v[192:193]
  v_cvt_pk_bf16_f32 v164, v180, v181
  v_rcp_f32 v114, v114
  v_cvt_pk_bf16_f32 v165, v182, v183
  v_rcp_f32 v115, v115
  buffer_store_dwordx2 v[164:165], v9, s[36:39], s56 offen
  v_pk_mul_f32 v[210:211], v[210:211], v[194:195]
  v_cvt_pk_bf16_f32 v168, v184, v185
  v_rcp_f32 v116, v116
  v_cvt_pk_bf16_f32 v169, v186, v187
  v_rcp_f32 v117, v117
  buffer_store_dwordx2 v[168:169], v9, s[36:39], s59 offen
  v_pk_mul_f32 v[212:213], v[212:213], v[196:197]
  v_cvt_pk_bf16_f32 v172, v188, v189
  v_rcp_f32 v118, v118
  v_cvt_pk_bf16_f32 v173, v190, v191
  v_rcp_f32 v119, v119
  buffer_store_dwordx2 v[172:173], v9, s[36:39], s62 offen
  v_pk_mul_f32 v[214:215], v[214:215], v[198:199]
  v_rcp_f32 v120, v120
  v_rcp_f32 v121, v121
  v_pk_mul_f32 v[216:217], v[216:217], v[200:201]
  v_rcp_f32 v122, v122
  v_rcp_f32 v123, v123
  v_pk_mul_f32 v[218:219], v[218:219], v[202:203]
  v_rcp_f32 v124, v124
  v_rcp_f32 v125, v125
  v_pk_mul_f32 v[220:221], v[220:221], v[204:205]
  v_rcp_f32 v126, v126
  v_rcp_f32 v127, v127
  v_pk_mul_f32 v[222:223], v[222:223], v[206:207]
  v_pk_mul_f32 v[208:209], v[208:209], v[112:113]
  v_pk_mul_f32 v[210:211], v[210:211], v[114:115]
  v_pk_mul_f32 v[212:213], v[212:213], v[116:117]
  v_pk_mul_f32 v[214:215], v[214:215], v[118:119]
  v_pk_mul_f32 v[216:217], v[216:217], v[120:121]
  v_pk_mul_f32 v[218:219], v[218:219], v[122:123]
  v_pk_mul_f32 v[220:221], v[220:221], v[124:125]
  v_pk_mul_f32 v[222:223], v[222:223], v[126:127]
  v_cvt_pk_bf16_f32 v192, v208, v209
  v_cvt_pk_bf16_f32 v193, v210, v211
  buffer_store_dwordx2 v[192:193], v9, s[36:39], s54 offen
  v_cvt_pk_bf16_f32 v196, v212, v213
  v_cvt_pk_bf16_f32 v197, v214, v215
  buffer_store_dwordx2 v[196:197], v9, s[36:39], s57 offen
  v_cvt_pk_bf16_f32 v200, v216, v217
  v_cvt_pk_bf16_f32 v201, v218, v219
  buffer_store_dwordx2 v[200:201], v9, s[36:39], s60 offen
  v_cvt_pk_bf16_f32 v204, v220, v221
  v_cvt_pk_bf16_f32 v205, v222, v223
  buffer_store_dwordx2 v[204:205], v9, s[36:39], s63 offen
gemm1_kernel_end:
  s_endpgm
.globl gemm2_kernel
.p2align 8
.type gemm2_kernel,@function
gemm2_kernel:
  s_cmp_ge_u32 s2, 256
  v_readfirstlane_b32 s96, v0
  s_cbranch_scc1 gemm2_kernel_end
  s_load_dwordx4 s[12:15], s[0:1], 72
  s_load_dwordx2 s[16:17], s[0:1], 96
  v_lshrrev_b32 v1, 6, v0
  v_and_b32 v2, 63, v0
  s_and_b32 s3, s2, 3
  s_lshr_b32 s4, s2, 3
  v_readfirstlane_b32 s8, v1
  s_and_b32 s5, s4, 7
  s_lshl_b32 s3, s3, 3
  s_add_u32 s3, s3, s5
  s_bfe_u32 s5, s2, 0x10002
  s_lshl_b32 s5, s5, 2
  s_lshr_b32 s4, s4, 3
  s_add_u32 s4, s4, s5
  v_lshrrev_b32 v3, 4, v2
  v_bfe_u32 v4, v2, 2, 2
  v_and_b32 v5, 3, v2
  v_and_b32 v6, 15, v2
  s_mul_i32 s6, s4, 160
  s_mov_b32 s7, 52429
  s_movk_i32 s11, 1280
  v_lshlrev_b32 v251, 4, v2
  s_mul_i32 s5, s4, 5120
  s_add_u32 s5, s5, 0
  v_add_u32 v236, s5, v251
  s_mul_i32 s5, s4, 5120
  s_add_u32 s5, s5, 1024
  v_add_u32 v237, s5, v251
  s_mul_i32 s5, s4, 5120
  s_add_u32 s5, s5, 2048
  v_add_u32 v238, s5, v251
  s_mul_i32 s5, s4, 5120
  s_add_u32 s5, s5, 3072
  v_add_u32 v239, s5, v251
  s_mul_i32 s5, s4, 5120
  s_add_u32 s5, s5, 4096
  v_add_u32 v240, s5, v251
  s_add_u32 s5, s8, 0
  s_and_b32 s5, s5, 3
  s_mul_i32 s5, s5, 50176
  v_add_u32 v241, s5, v251
  s_add_u32 s5, s8, 1
  s_and_b32 s5, s5, 3
  s_mul_i32 s5, s5, 50176
  v_add_u32 v242, s5, v251
  s_add_u32 s5, s8, 2
  s_and_b32 s5, s5, 3
  s_mul_i32 s5, s5, 50176
  v_add_u32 v243, s5, v251
  s_add_u32 s5, s8, 3
  s_and_b32 s5, s5, 3
  s_mul_i32 s5, s5, 50176
  v_add_u32 v244, s5, v251
  s_mul_i32 s44, s8, 491520
  s_add_u32 s44, s44, 18874368
  s_mul_i32 s45, s3, 200704
  s_mul_i32 s5, s8, 12288
  s_add_u32 s45, s45, s5
  s_add_u32 s45, s45, 10485760
  s_add_u32 s46, s45, 4096
  s_add_u32 s47, s45, 8192
  s_mul_i32 s48, s8, 20480
  s_waitcnt lgkmcnt(0)
  s_mov_b32 s36, s16
  s_and_b32 s37, s17, 0xffff
  s_mov_b32 s38, 268435456
  s_mov_b32 s39, 0x00020000
  s_mov_b32 s20, s14
  s_and_b32 s21, s15, 0xffff
  s_mov_b32 s22, 2621440
  s_mov_b32 s23, 0x00020000
  s_add_u32 m0, s48, 0
  s_nop 0
  buffer_load_dwordx4 v236, s[36:39], s44 offen lds
  s_add_u32 m0, s48, 1024
  s_nop 0
  buffer_load_dwordx4 v237, s[36:39], s44 offen lds
  s_add_u32 m0, s48, 2048
  s_nop 0
  buffer_load_dwordx4 v238, s[36:39], s44 offen lds
  s_add_u32 m0, s48, 3072
  s_nop 0
  buffer_load_dwordx4 v239, s[36:39], s44 offen lds
  s_add_u32 m0, s48, 4096
  s_nop 0
  buffer_load_dwordx4 v240, s[36:39], s44 offen lds
  s_add_u32 s44, s44, 40960
  buffer_load_dwordx4 v[120:123], v241, s[36:39], s45 offen offset:0
  buffer_load_dwordx4 v[124:127], v242, s[36:39], s45 offen offset:0
  buffer_load_dwordx4 v[128:131], v243, s[36:39], s45 offen offset:0
  buffer_load_dwordx4 v[132:135], v244, s[36:39], s45 offen offset:0
  s_add_u32 m0, s48, 5120
  s_nop 0
  buffer_load_dwordx4 v236, s[36:39], s44 offen lds
  s_add_u32 m0, s48, 6144
  s_nop 0
  buffer_load_dwordx4 v237, s[36:39], s44 offen lds
  s_add_u32 m0, s48, 7168
  s_nop 0
  buffer_load_dwordx4 v238, s[36:39], s44 offen lds
  s_add_u32 m0, s48, 8192
  s_nop 0
  buffer_load_dwordx4 v239, s[36:39], s44 offen lds
  s_add_u32 m0, s48, 9216
  s_nop 0
  buffer_load_dwordx4 v240, s[36:39], s44 offen lds
  s_add_u32 s44, s44, 40960
  buffer_load_dwordx4 v[136:139], v241, s[36:39], s45 offen offset:1024
  buffer_load_dwordx4 v[140:143], v242, s[36:39], s45 offen offset:1024
  buffer_load_dwordx4 v[144:147], v243, s[36:39], s45 offen offset:1024
  buffer_load_dwordx4 v[148:151], v244, s[36:39], s45 offen offset:1024
  s_add_u32 m0, s48, 10240
  s_nop 0
  buffer_load_dwordx4 v236, s[36:39], s44 offen lds
  s_add_u32 m0, s48, 11264
  s_nop 0
  buffer_load_dwordx4 v237, s[36:39], s44 offen lds
  s_add_u32 m0, s48, 12288
  s_nop 0
  buffer_load_dwordx4 v238, s[36:39], s44 offen lds
  s_add_u32 m0, s48, 13312
  s_nop 0
  buffer_load_dwordx4 v239, s[36:39], s44 offen lds
  s_add_u32 m0, s48, 14336
  s_nop 0
  buffer_load_dwordx4 v240, s[36:39], s44 offen lds
  s_add_u32 s44, s44, 40960
  buffer_load_dwordx4 v[152:155], v241, s[36:39], s45 offen offset:2048
  buffer_load_dwordx4 v[156:159], v242, s[36:39], s45 offen offset:2048
  buffer_load_dwordx4 v[160:163], v243, s[36:39], s45 offen offset:2048
  buffer_load_dwordx4 v[164:167], v244, s[36:39], s45 offen offset:2048
  s_add_u32 m0, s48, 15360
  s_nop 0
  buffer_load_dwordx4 v236, s[36:39], s44 offen lds
  s_add_u32 m0, s48, 16384
  s_nop 0
  buffer_load_dwordx4 v237, s[36:39], s44 offen lds
  s_add_u32 m0, s48, 17408
  s_nop 0
  buffer_load_dwordx4 v238, s[36:39], s44 offen lds
  s_add_u32 m0, s48, 18432
  s_nop 0
  buffer_load_dwordx4 v239, s[36:39], s44 offen lds
  s_add_u32 m0, s48, 19456
  s_nop 0
  buffer_load_dwordx4 v240, s[36:39], s44 offen lds
  s_add_u32 s44, s44, 40960
  buffer_load_dwordx4 v[168:171], v241, s[36:39], s45 offen offset:3072
  buffer_load_dwordx4 v[172:175], v242, s[36:39], s45 offen offset:3072
  buffer_load_dwordx4 v[176:179], v243, s[36:39], s45 offen offset:3072
  buffer_load_dwordx4 v[180:183], v244, s[36:39], s45 offen offset:3072
  v_lshl_add_u32 v7, v3, 2, v4
  s_movk_i32 s5, 160
  v_mul_u32_u24 v7, s5, v7
  v_lshl_add_u32 v7, v5, 3, v7
  v_add_u32 v245, s48, v7
  v_add_u32 v246, s48, v251
  s_sub_u32 s5, s8, 1
  s_and_b32 s5, s5, 3
  s_mul_i32 s5, s5, 20480
  v_add_u32 v200, s5, v251
  s_sub_u32 s5, s8, 2
  s_and_b32 s5, s5, 3
  s_mul_i32 s5, s5, 20480
  v_add_u32 v201, s5, v251
  s_sub_u32 s5, s8, 3
  s_and_b32 s5, s5, 3
  s_mul_i32 s5, s5, 20480
  v_add_u32 v202, s5, v251
  s_lshl_b32 s49, s8, 10
  s_add_u32 s49, s49, 81920
  v_lshrrev_b32 v203, 2, v2
  v_lshlrev_b32 v203, 7, v203
  v_lshl_add_u32 v203, v5, 3, v203
  s_lshl_b32 s5, s8, 5
  s_add_u32 s5, s5, 81920
  v_add_u32 v203, s5, v203
  s_lshl_b32 s5, s3, 6
  s_lshl_b32 s7, s8, 4
  s_add_u32 s5, s5, s7
  v_add_u32 v7, s5, v6
  s_mul_i32 s5, s4, 80
  v_lshl_add_u32 v8, v3, 2, s5
  v_mul_u32_u24 v250, s11, v7
  v_lshl_add_u32 v250, v8, 1, v250
  v_lshrrev_b32 v9, 3, v2
  s_lshl_b32 s7, s8, 3
  s_add_u32 s5, s5, s7
  v_add_u32 v9, s5, v9
  s_movk_i32 s5, 4352
  v_mul_u32_u24 v249, s5, v9
  v_and_b32 v9, 7, v2
  v_lshl_add_u32 v249, v9, 4, v249
  s_lshl_b32 s5, s3, 7
  v_add_u32 v249, s5, v249
  s_cmp_ge_u32 s8, 2
  s_cselect_b32 s7, 0, -1
  v_and_b32 v248, s7, v249
  s_mul_i32 s5, s8, 2560
  s_add_u32 s5, s5, 94208
  v_add_u32 v191, s5, v251
  s_movk_i32 s7, 160
  v_mul_u32_u24 v190, s7, v6
  v_lshl_add_u32 v190, v3, 3, v190
  v_add_u32 v190, s5, v190
  s_mov_b32 s7, 52429
  v_add_u32 v7, 0, v2
  v_mul_u32_u24 v8, s7, v7
  v_lshrrev_b32 v8, 19, v8
  v_mul_u32_u24 v9, 10, v8
  v_sub_u32 v9, v7, v9
  v_mul_u32_u24 v8, s11, v8
  v_lshl_add_u32 v192, v9, 4, v8
  v_add_u32 v7, 64, v2
  v_mul_u32_u24 v8, s7, v7
  v_lshrrev_b32 v8, 19, v8
  v_mul_u32_u24 v9, 10, v8
  v_sub_u32 v9, v7, v9
  v_mul_u32_u24 v8, s11, v8
  v_lshl_add_u32 v193, v9, 4, v8
  v_add_u32 v7, 128, v2
  v_mul_u32_u24 v8, s7, v7
  v_lshrrev_b32 v8, 19, v8
  v_mul_u32_u24 v9, 10, v8
  v_sub_u32 v9, v7, v9
  v_mul_u32_u24 v8, s11, v8
  v_lshl_add_u32 v194, v9, 4, v8
  s_lshl_b32 s5, s3, 2
  s_add_u32 s5, s5, s8
  s_mul_i32 s5, s5, 20480
  s_add_u32 s50, s5, s6
  s_waitcnt vmcnt(31)
  ds_read_b64_tr_b16 v[80:81], v245 offset:0
  ds_read_b64_tr_b16 v[82:83], v245 offset:2560
  ds_read_b64_tr_b16 v[84:85], v245 offset:32
  ds_read_b64_tr_b16 v[86:87], v245 offset:2592
  ds_read_b64_tr_b16 v[88:89], v245 offset:64
  ds_read_b64_tr_b16 v[90:91], v245 offset:2624
  ds_read_b64_tr_b16 v[92:93], v245 offset:96
  ds_read_b64_tr_b16 v[94:95], v245 offset:2656
  ds_read_b64_tr_b16 v[96:97], v245 offset:128
  ds_read_b64_tr_b16 v[98:99], v245 offset:2688
  s_waitcnt lgkmcnt(0)
  s_waitcnt vmcnt(22)
  v_mfma_f32_16x16x32_bf16 v[0:3], v[80:83], v[120:123], 0
  ds_read_b64_tr_b16 v[100:101], v245 offset:5120
  v_mfma_f32_16x16x32_bf16 v[4:7], v[84:87], v[120:123], 0
  ds_read_b64_tr_b16 v[102:103], v245 offset:7680
  v_mfma_f32_16x16x32_bf16 v[8:11], v[88:91], v[120:123], 0
  ds_read_b64_tr_b16 v[104:105], v245 offset:5152
  v_mfma_f32_16x16x32_bf16 v[12:15], v[92:95], v[120:123], 0
  ds_read_b64_tr_b16 v[106:107], v245 offset:7712
  v_mfma_f32_16x16x32_bf16 v[16:19], v[96:99], v[120:123], 0
  ds_read_b64_tr_b16 v[108:109], v245 offset:5184
  buffer_load_dwordx4 v[120:123], v241, s[36:39], s46 offen offset:0
  v_mfma_f32_16x16x32_bf16 v[20:23], v[80:83], v[124:127], 0
  ds_read_b64_tr_b16 v[110:111], v245 offset:7744
  v_mfma_f32_16x16x32_bf16 v[24:27], v[84:87], v[124:127], 0
  ds_read_b64_tr_b16 v[112:113], v245 offset:5216
  v_mfma_f32_16x16x32_bf16 v[28:31], v[88:91], v[124:127], 0
  ds_read_b64_tr_b16 v[114:115], v245 offset:7776
  v_mfma_f32_16x16x32_bf16 v[32:35], v[92:95], v[124:127], 0
  ds_read_b64_tr_b16 v[116:117], v245 offset:5248
  v_mfma_f32_16x16x32_bf16 v[36:39], v[96:99], v[124:127], 0
  ds_read_b64_tr_b16 v[118:119], v245 offset:7808
  buffer_load_dwordx4 v[124:127], v242, s[36:39], s46 offen offset:0
  v_mfma_f32_16x16x32_bf16 v[40:43], v[80:83], v[128:131], 0
  s_add_u32 m0, s48, 0
  s_nop 0
  buffer_load_dwordx4 v236, s[36:39], s44 offen lds
  v_mfma_f32_16x16x32_bf16 v[44:47], v[84:87], v[128:131], 0
  s_add_u32 m0, s48, 1024
  s_nop 0
  buffer_load_dwordx4 v237, s[36:39], s44 offen lds
  v_mfma_f32_16x16x32_bf16 v[48:51], v[88:91], v[128:131], 0
  s_add_u32 m0, s48, 2048
  s_nop 0
  buffer_load_dwordx4 v238, s[36:39], s44 offen lds
  v_mfma_f32_16x16x32_bf16 v[52:55], v[92:95], v[128:131], 0
  s_add_u32 m0, s48, 3072
  s_nop 0
  buffer_load_dwordx4 v239, s[36:39], s44 offen lds
  v_mfma_f32_16x16x32_bf16 v[56:59], v[96:99], v[128:131], 0
  s_add_u32 m0, s48, 4096
  s_nop 0
  buffer_load_dwordx4 v240, s[36:39], s44 offen lds
  s_add_u32 s44, s44, 40960
  buffer_load_dwordx4 v[128:131], v243, s[36:39], s46 offen offset:0
  v_mfma_f32_16x16x32_bf16 v[60:63], v[80:83], v[132:135], 0
  v_mfma_f32_16x16x32_bf16 v[64:67], v[84:87], v[132:135], 0
  v_mfma_f32_16x16x32_bf16 v[68:71], v[88:91], v[132:135], 0
  v_mfma_f32_16x16x32_bf16 v[72:75], v[92:95], v[132:135], 0
  v_mfma_f32_16x16x32_bf16 v[76:79], v[96:99], v[132:135], 0
  buffer_load_dwordx4 v[132:135], v244, s[36:39], s46 offen offset:0
  s_waitcnt lgkmcnt(0)
  s_waitcnt vmcnt(22)
  v_mfma_f32_16x16x32_bf16 v[0:3], v[100:103], v[136:139], v[0:3]
  ds_read_b64_tr_b16 v[80:81], v245 offset:10240
  v_mfma_f32_16x16x32_bf16 v[4:7], v[104:107], v[136:139], v[4:7]
  ds_read_b64_tr_b16 v[82:83], v245 offset:12800
  v_mfma_f32_16x16x32_bf16 v[8:11], v[108:111], v[136:139], v[8:11]
  ds_read_b64_tr_b16 v[84:85], v245 offset:10272
  v_mfma_f32_16x16x32_bf16 v[12:15], v[112:115], v[136:139], v[12:15]
  ds_read_b64_tr_b16 v[86:87], v245 offset:12832
  v_mfma_f32_16x16x32_bf16 v[16:19], v[116:119], v[136:139], v[16:19]
  ds_read_b64_tr_b16 v[88:89], v245 offset:10304
  buffer_load_dwordx4 v[136:139], v241, s[36:39], s46 offen offset:1024
  v_mfma_f32_16x16x32_bf16 v[20:23], v[100:103], v[140:143], v[20:23]
  ds_read_b64_tr_b16 v[90:91], v245 offset:12864
  v_mfma_f32_16x16x32_bf16 v[24:27], v[104:107], v[140:143], v[24:27]
  ds_read_b64_tr_b16 v[92:93], v245 offset:10336
  v_mfma_f32_16x16x32_bf16 v[28:31], v[108:111], v[140:143], v[28:31]
  ds_read_b64_tr_b16 v[94:95], v245 offset:12896
  v_mfma_f32_16x16x32_bf16 v[32:35], v[112:115], v[140:143], v[32:35]
  ds_read_b64_tr_b16 v[96:97], v245 offset:10368
  v_mfma_f32_16x16x32_bf16 v[36:39], v[116:119], v[140:143], v[36:39]
  ds_read_b64_tr_b16 v[98:99], v245 offset:12928
  buffer_load_dwordx4 v[140:143], v242, s[36:39], s46 offen offset:1024
  v_mfma_f32_16x16x32_bf16 v[40:43], v[100:103], v[144:147], v[40:43]
  s_add_u32 m0, s48, 5120
  s_nop 0
  buffer_load_dwordx4 v236, s[36:39], s44 offen lds
  v_mfma_f32_16x16x32_bf16 v[44:47], v[104:107], v[144:147], v[44:47]
  s_add_u32 m0, s48, 6144
  s_nop 0
  buffer_load_dwordx4 v237, s[36:39], s44 offen lds
  v_mfma_f32_16x16x32_bf16 v[48:51], v[108:111], v[144:147], v[48:51]
  s_add_u32 m0, s48, 7168
  s_nop 0
  buffer_load_dwordx4 v238, s[36:39], s44 offen lds
  v_mfma_f32_16x16x32_bf16 v[52:55], v[112:115], v[144:147], v[52:55]
  s_add_u32 m0, s48, 8192
  s_nop 0
  buffer_load_dwordx4 v239, s[36:39], s44 offen lds
  v_mfma_f32_16x16x32_bf16 v[56:59], v[116:119], v[144:147], v[56:59]
  s_add_u32 m0, s48, 9216
  s_nop 0
  buffer_load_dwordx4 v240, s[36:39], s44 offen lds
  s_add_u32 s44, s44, 40960
  buffer_load_dwordx4 v[144:147], v243, s[36:39], s46 offen offset:1024
  v_mfma_f32_16x16x32_bf16 v[60:63], v[100:103], v[148:151], v[60:63]
  v_mfma_f32_16x16x32_bf16 v[64:67], v[104:107], v[148:151], v[64:67]
  v_mfma_f32_16x16x32_bf16 v[68:71], v[108:111], v[148:151], v[68:71]
  v_mfma_f32_16x16x32_bf16 v[72:75], v[112:115], v[148:151], v[72:75]
  v_mfma_f32_16x16x32_bf16 v[76:79], v[116:119], v[148:151], v[76:79]
  buffer_load_dwordx4 v[148:151], v244, s[36:39], s46 offen offset:1024
  s_waitcnt lgkmcnt(0)
  s_waitcnt vmcnt(22)
  v_mfma_f32_16x16x32_bf16 v[0:3], v[80:83], v[152:155], v[0:3]
  ds_read_b64_tr_b16 v[100:101], v245 offset:15360
  v_mfma_f32_16x16x32_bf16 v[4:7], v[84:87], v[152:155], v[4:7]
  ds_read_b64_tr_b16 v[102:103], v245 offset:17920
  v_mfma_f32_16x16x32_bf16 v[8:11], v[88:91], v[152:155], v[8:11]
  ds_read_b64_tr_b16 v[104:105], v245 offset:15392
  v_mfma_f32_16x16x32_bf16 v[12:15], v[92:95], v[152:155], v[12:15]
  ds_read_b64_tr_b16 v[106:107], v245 offset:17952
  v_mfma_f32_16x16x32_bf16 v[16:19], v[96:99], v[152:155], v[16:19]
  ds_read_b64_tr_b16 v[108:109], v245 offset:15424
  buffer_load_dwordx4 v[152:155], v241, s[36:39], s46 offen offset:2048
  v_mfma_f32_16x16x32_bf16 v[20:23], v[80:83], v[156:159], v[20:23]
  ds_read_b64_tr_b16 v[110:111], v245 offset:17984
  v_mfma_f32_16x16x32_bf16 v[24:27], v[84:87], v[156:159], v[24:27]
  ds_read_b64_tr_b16 v[112:113], v245 offset:15456
  v_mfma_f32_16x16x32_bf16 v[28:31], v[88:91], v[156:159], v[28:31]
  ds_read_b64_tr_b16 v[114:115], v245 offset:18016
  v_mfma_f32_16x16x32_bf16 v[32:35], v[92:95], v[156:159], v[32:35]
  ds_read_b64_tr_b16 v[116:117], v245 offset:15488
  v_mfma_f32_16x16x32_bf16 v[36:39], v[96:99], v[156:159], v[36:39]
  ds_read_b64_tr_b16 v[118:119], v245 offset:18048
  buffer_load_dwordx4 v[156:159], v242, s[36:39], s46 offen offset:2048
  v_mfma_f32_16x16x32_bf16 v[40:43], v[80:83], v[160:163], v[40:43]
  s_add_u32 m0, s48, 10240
  s_nop 0
  buffer_load_dwordx4 v236, s[36:39], s44 offen lds
  v_mfma_f32_16x16x32_bf16 v[44:47], v[84:87], v[160:163], v[44:47]
  s_add_u32 m0, s48, 11264
  s_nop 0
  buffer_load_dwordx4 v237, s[36:39], s44 offen lds
  v_mfma_f32_16x16x32_bf16 v[48:51], v[88:91], v[160:163], v[48:51]
  s_add_u32 m0, s48, 12288
  s_nop 0
  buffer_load_dwordx4 v238, s[36:39], s44 offen lds
  v_mfma_f32_16x16x32_bf16 v[52:55], v[92:95], v[160:163], v[52:55]
  s_add_u32 m0, s48, 13312
  s_nop 0
  buffer_load_dwordx4 v239, s[36:39], s44 offen lds
  v_mfma_f32_16x16x32_bf16 v[56:59], v[96:99], v[160:163], v[56:59]
  s_add_u32 m0, s48, 14336
  s_nop 0
  buffer_load_dwordx4 v240, s[36:39], s44 offen lds
  s_add_u32 s44, s44, 40960
  buffer_load_dwordx4 v[160:163], v243, s[36:39], s46 offen offset:2048
  v_mfma_f32_16x16x32_bf16 v[60:63], v[80:83], v[164:167], v[60:63]
  v_mfma_f32_16x16x32_bf16 v[64:67], v[84:87], v[164:167], v[64:67]
  v_mfma_f32_16x16x32_bf16 v[68:71], v[88:91], v[164:167], v[68:71]
  v_mfma_f32_16x16x32_bf16 v[72:75], v[92:95], v[164:167], v[72:75]
  v_mfma_f32_16x16x32_bf16 v[76:79], v[96:99], v[164:167], v[76:79]
  buffer_load_dwordx4 v[164:167], v244, s[36:39], s46 offen offset:2048
  s_waitcnt lgkmcnt(0)
  s_waitcnt vmcnt(20)
  v_mfma_f32_16x16x32_bf16 v[0:3], v[100:103], v[168:171], v[0:3]
  ds_read_b64_tr_b16 v[80:81], v245 offset:0
  v_mfma_f32_16x16x32_bf16 v[4:7], v[104:107], v[168:171], v[4:7]
  ds_read_b64_tr_b16 v[82:83], v245 offset:2560
  v_mfma_f32_16x16x32_bf16 v[8:11], v[108:111], v[168:171], v[8:11]
  ds_read_b64_tr_b16 v[84:85], v245 offset:32
  v_mfma_f32_16x16x32_bf16 v[12:15], v[112:115], v[168:171], v[12:15]
  ds_read_b64_tr_b16 v[86:87], v245 offset:2592
  v_mfma_f32_16x16x32_bf16 v[16:19], v[116:119], v[168:171], v[16:19]
  ds_read_b64_tr_b16 v[88:89], v245 offset:64
  buffer_load_dwordx4 v[168:171], v241, s[36:39], s46 offen offset:3072
  v_mfma_f32_16x16x32_bf16 v[20:23], v[100:103], v[172:175], v[20:23]
  ds_read_b64_tr_b16 v[90:91], v245 offset:2624
  v_mfma_f32_16x16x32_bf16 v[24:27], v[104:107], v[172:175], v[24:27]
  ds_read_b64_tr_b16 v[92:93], v245 offset:96
  v_mfma_f32_16x16x32_bf16 v[28:31], v[108:111], v[172:175], v[28:31]
  ds_read_b64_tr_b16 v[94:95], v245 offset:2656
  v_mfma_f32_16x16x32_bf16 v[32:35], v[112:115], v[172:175], v[32:35]
  ds_read_b64_tr_b16 v[96:97], v245 offset:128
  v_mfma_f32_16x16x32_bf16 v[36:39], v[116:119], v[172:175], v[36:39]
  ds_read_b64_tr_b16 v[98:99], v245 offset:2688
  buffer_load_dwordx4 v[172:175], v242, s[36:39], s46 offen offset:3072
  v_mfma_f32_16x16x32_bf16 v[40:43], v[100:103], v[176:179], v[40:43]
  s_add_u32 m0, s48, 15360
  s_nop 0
  buffer_load_dwordx4 v236, s[36:39], s44 offen lds
  v_mfma_f32_16x16x32_bf16 v[44:47], v[104:107], v[176:179], v[44:47]
  s_add_u32 m0, s48, 16384
  s_nop 0
  buffer_load_dwordx4 v237, s[36:39], s44 offen lds
  v_mfma_f32_16x16x32_bf16 v[48:51], v[108:111], v[176:179], v[48:51]
  s_add_u32 m0, s48, 17408
  s_nop 0
  buffer_load_dwordx4 v238, s[36:39], s44 offen lds
  v_mfma_f32_16x16x32_bf16 v[52:55], v[112:115], v[176:179], v[52:55]
  s_add_u32 m0, s48, 18432
  s_nop 0
  buffer_load_dwordx4 v239, s[36:39], s44 offen lds
  v_mfma_f32_16x16x32_bf16 v[56:59], v[116:119], v[176:179], v[56:59]
  s_add_u32 m0, s48, 19456
  s_nop 0
  buffer_load_dwordx4 v240, s[36:39], s44 offen lds
  s_add_u32 s44, s44, 40960
  buffer_load_dwordx4 v[176:179], v243, s[36:39], s46 offen offset:3072
  v_mfma_f32_16x16x32_bf16 v[60:63], v[100:103], v[180:183], v[60:63]
  v_mfma_f32_16x16x32_bf16 v[64:67], v[104:107], v[180:183], v[64:67]
  v_mfma_f32_16x16x32_bf16 v[68:71], v[108:111], v[180:183], v[68:71]
  v_mfma_f32_16x16x32_bf16 v[72:75], v[112:115], v[180:183], v[72:75]
  v_mfma_f32_16x16x32_bf16 v[76:79], v[116:119], v[180:183], v[76:79]
  buffer_load_dwordx4 v[180:183], v244, s[36:39], s46 offen offset:3072
  s_waitcnt lgkmcnt(0)
  s_waitcnt vmcnt(20)
  v_mfma_f32_16x16x32_bf16 v[0:3], v[80:83], v[120:123], v[0:3]
  ds_read_b64_tr_b16 v[100:101], v245 offset:5120
  v_mfma_f32_16x16x32_bf16 v[4:7], v[84:87], v[120:123], v[4:7]
  ds_read_b64_tr_b16 v[102:103], v245 offset:7680
  v_mfma_f32_16x16x32_bf16 v[8:11], v[88:91], v[120:123], v[8:11]
  ds_read_b64_tr_b16 v[104:105], v245 offset:5152
  v_mfma_f32_16x16x32_bf16 v[12:15], v[92:95], v[120:123], v[12:15]
  ds_read_b64_tr_b16 v[106:107], v245 offset:7712
  v_mfma_f32_16x16x32_bf16 v[16:19], v[96:99], v[120:123], v[16:19]
  ds_read_b64_tr_b16 v[108:109], v245 offset:5184
  buffer_load_dwordx4 v[120:123], v241, s[36:39], s47 offen offset:0
  v_mfma_f32_16x16x32_bf16 v[20:23], v[80:83], v[124:127], v[20:23]
  ds_read_b64_tr_b16 v[110:111], v245 offset:7744
  v_mfma_f32_16x16x32_bf16 v[24:27], v[84:87], v[124:127], v[24:27]
  ds_read_b64_tr_b16 v[112:113], v245 offset:5216
  v_mfma_f32_16x16x32_bf16 v[28:31], v[88:91], v[124:127], v[28:31]
  ds_read_b64_tr_b16 v[114:115], v245 offset:7776
  v_mfma_f32_16x16x32_bf16 v[32:35], v[92:95], v[124:127], v[32:35]
  ds_read_b64_tr_b16 v[116:117], v245 offset:5248
  v_mfma_f32_16x16x32_bf16 v[36:39], v[96:99], v[124:127], v[36:39]
  ds_read_b64_tr_b16 v[118:119], v245 offset:7808
  buffer_load_dwordx4 v[124:127], v242, s[36:39], s47 offen offset:0
  v_mfma_f32_16x16x32_bf16 v[40:43], v[80:83], v[128:131], v[40:43]
  s_add_u32 m0, s48, 0
  s_nop 0
  buffer_load_dwordx4 v236, s[36:39], s44 offen lds
  v_mfma_f32_16x16x32_bf16 v[44:47], v[84:87], v[128:131], v[44:47]
  s_add_u32 m0, s48, 1024
  s_nop 0
  buffer_load_dwordx4 v237, s[36:39], s44 offen lds
  v_mfma_f32_16x16x32_bf16 v[48:51], v[88:91], v[128:131], v[48:51]
  s_add_u32 m0, s48, 2048
  s_nop 0
  buffer_load_dwordx4 v238, s[36:39], s44 offen lds
  v_mfma_f32_16x16x32_bf16 v[52:55], v[92:95], v[128:131], v[52:55]
  s_add_u32 m0, s48, 3072
  s_nop 0
  buffer_load_dwordx4 v239, s[36:39], s44 offen lds
  v_mfma_f32_16x16x32_bf16 v[56:59], v[96:99], v[128:131], v[56:59]
  s_add_u32 m0, s48, 4096
  s_nop 0
  buffer_load_dwordx4 v240, s[36:39], s44 offen lds
  s_add_u32 s44, s44, 40960
  buffer_load_dwordx4 v[128:131], v243, s[36:39], s47 offen offset:0
  v_mfma_f32_16x16x32_bf16 v[60:63], v[80:83], v[132:135], v[60:63]
  s_add_u32 m0, s49, 0
  s_mov_b32 s5, 5636096
  buffer_load_dwordx4 v249, s[36:39], s5 offen lds
  v_mfma_f32_16x16x32_bf16 v[64:67], v[84:87], v[132:135], v[64:67]
  s_add_u32 m0, s49, 4096
  s_mov_b32 s5, 5775360
  buffer_load_dwordx4 v249, s[36:39], s5 offen lds
  v_mfma_f32_16x16x32_bf16 v[68:71], v[88:91], v[132:135], v[68:71]
  s_add_u32 m0, s49, 8192
  s_mov_b32 s5, 5914624
  buffer_load_dwordx4 v248, s[36:39], s5 offen lds
  v_mfma_f32_16x16x32_bf16 v[72:75], v[92:95], v[132:135], v[72:75]
  v_mfma_f32_16x16x32_bf16 v[76:79], v[96:99], v[132:135], v[76:79]
  buffer_load_dwordx4 v[132:135], v244, s[36:39], s47 offen offset:0
  s_waitcnt lgkmcnt(0)
  s_waitcnt vmcnt(23)
  v_mfma_f32_16x16x32_bf16 v[0:3], v[100:103], v[136:139], v[0:3]
  ds_read_b64_tr_b16 v[80:81], v245 offset:10240
  v_mfma_f32_16x16x32_bf16 v[4:7], v[104:107], v[136:139], v[4:7]
  ds_read_b64_tr_b16 v[82:83], v245 offset:12800
  v_mfma_f32_16x16x32_bf16 v[8:11], v[108:111], v[136:139], v[8:11]
  ds_read_b64_tr_b16 v[84:85], v245 offset:10272
  v_mfma_f32_16x16x32_bf16 v[12:15], v[112:115], v[136:139], v[12:15]
  ds_read_b64_tr_b16 v[86:87], v245 offset:12832
  v_mfma_f32_16x16x32_bf16 v[16:19], v[116:119], v[136:139], v[16:19]
  ds_read_b64_tr_b16 v[88:89], v245 offset:10304
  buffer_load_dwordx4 v[136:139], v241, s[36:39], s47 offen offset:1024
  v_mfma_f32_16x16x32_bf16 v[20:23], v[100:103], v[140:143], v[20:23]
  ds_read_b64_tr_b16 v[90:91], v245 offset:12864
  v_mfma_f32_16x16x32_bf16 v[24:27], v[104:107], v[140:143], v[24:27]
  ds_read_b64_tr_b16 v[92:93], v245 offset:10336
  v_mfma_f32_16x16x32_bf16 v[28:31], v[108:111], v[140:143], v[28:31]
  ds_read_b64_tr_b16 v[94:95], v245 offset:12896
  v_mfma_f32_16x16x32_bf16 v[32:35], v[112:115], v[140:143], v[32:35]
  ds_read_b64_tr_b16 v[96:97], v245 offset:10368
  v_mfma_f32_16x16x32_bf16 v[36:39], v[116:119], v[140:143], v[36:39]
  ds_read_b64_tr_b16 v[98:99], v245 offset:12928
  buffer_load_dwordx4 v[140:143], v242, s[36:39], s47 offen offset:1024
  v_mfma_f32_16x16x32_bf16 v[40:43], v[100:103], v[144:147], v[40:43]
  s_add_u32 m0, s48, 5120
  s_nop 0
  buffer_load_dwordx4 v236, s[36:39], s44 offen lds
  v_mfma_f32_16x16x32_bf16 v[44:47], v[104:107], v[144:147], v[44:47]
  s_add_u32 m0, s48, 6144
  s_nop 0
  buffer_load_dwordx4 v237, s[36:39], s44 offen lds
  v_mfma_f32_16x16x32_bf16 v[48:51], v[108:111], v[144:147], v[48:51]
  s_add_u32 m0, s48, 7168
  s_nop 0
  buffer_load_dwordx4 v238, s[36:39], s44 offen lds
  v_mfma_f32_16x16x32_bf16 v[52:55], v[112:115], v[144:147], v[52:55]
  s_add_u32 m0, s48, 8192
  s_nop 0
  buffer_load_dwordx4 v239, s[36:39], s44 offen lds
  v_mfma_f32_16x16x32_bf16 v[56:59], v[116:119], v[144:147], v[56:59]
  s_add_u32 m0, s48, 9216
  s_nop 0
  buffer_load_dwordx4 v240, s[36:39], s44 offen lds
  s_add_u32 s44, s44, 40960
  buffer_load_dwordx4 v[144:147], v243, s[36:39], s47 offen offset:1024
  v_mfma_f32_16x16x32_bf16 v[60:63], v[100:103], v[148:151], v[60:63]
  v_mfma_f32_16x16x32_bf16 v[64:67], v[104:107], v[148:151], v[64:67]
  v_mfma_f32_16x16x32_bf16 v[68:71], v[108:111], v[148:151], v[68:71]
  v_mfma_f32_16x16x32_bf16 v[72:75], v[112:115], v[148:151], v[72:75]
  v_mfma_f32_16x16x32_bf16 v[76:79], v[116:119], v[148:151], v[76:79]
  buffer_load_dwordx4 v[148:151], v244, s[36:39], s47 offen offset:1024
  s_waitcnt lgkmcnt(0)
  s_waitcnt vmcnt(23)
  v_mfma_f32_16x16x32_bf16 v[0:3], v[80:83], v[152:155], v[0:3]
  ds_read_b64_tr_b16 v[100:101], v245 offset:15360
  v_mfma_f32_16x16x32_bf16 v[4:7], v[84:87], v[152:155], v[4:7]
  ds_read_b64_tr_b16 v[102:103], v245 offset:17920
  v_mfma_f32_16x16x32_bf16 v[8:11], v[88:91], v[152:155], v[8:11]
  ds_read_b64_tr_b16 v[104:105], v245 offset:15392
  v_mfma_f32_16x16x32_bf16 v[12:15], v[92:95], v[152:155], v[12:15]
  ds_read_b64_tr_b16 v[106:107], v245 offset:17952
  v_mfma_f32_16x16x32_bf16 v[16:19], v[96:99], v[152:155], v[16:19]
  ds_read_b64_tr_b16 v[108:109], v245 offset:15424
  buffer_load_dwordx4 v[152:155], v241, s[36:39], s47 offen offset:2048
  v_mfma_f32_16x16x32_bf16 v[20:23], v[80:83], v[156:159], v[20:23]
  ds_read_b64_tr_b16 v[110:111], v245 offset:17984
  v_mfma_f32_16x16x32_bf16 v[24:27], v[84:87], v[156:159], v[24:27]
  ds_read_b64_tr_b16 v[112:113], v245 offset:15456
  v_mfma_f32_16x16x32_bf16 v[28:31], v[88:91], v[156:159], v[28:31]
  ds_read_b64_tr_b16 v[114:115], v245 offset:18016
  v_mfma_f32_16x16x32_bf16 v[32:35], v[92:95], v[156:159], v[32:35]
  ds_read_b64_tr_b16 v[116:117], v245 offset:15488
  v_mfma_f32_16x16x32_bf16 v[36:39], v[96:99], v[156:159], v[36:39]
  ds_read_b64_tr_b16 v[118:119], v245 offset:18048
  buffer_load_dwordx4 v[156:159], v242, s[36:39], s47 offen offset:2048
  v_mfma_f32_16x16x32_bf16 v[40:43], v[80:83], v[160:163], v[40:43]
  s_add_u32 m0, s48, 10240
  s_nop 0
  buffer_load_dwordx4 v236, s[36:39], s44 offen lds
  v_mfma_f32_16x16x32_bf16 v[44:47], v[84:87], v[160:163], v[44:47]
  s_add_u32 m0, s48, 11264
  s_nop 0
  buffer_load_dwordx4 v237, s[36:39], s44 offen lds
  v_mfma_f32_16x16x32_bf16 v[48:51], v[88:91], v[160:163], v[48:51]
  s_add_u32 m0, s48, 12288
  s_nop 0
  buffer_load_dwordx4 v238, s[36:39], s44 offen lds
  v_mfma_f32_16x16x32_bf16 v[52:55], v[92:95], v[160:163], v[52:55]
  s_add_u32 m0, s48, 13312
  s_nop 0
  buffer_load_dwordx4 v239, s[36:39], s44 offen lds
  v_mfma_f32_16x16x32_bf16 v[56:59], v[96:99], v[160:163], v[56:59]
  s_add_u32 m0, s48, 14336
  s_nop 0
  buffer_load_dwordx4 v240, s[36:39], s44 offen lds
  s_add_u32 s44, s44, 40960
  buffer_load_dwordx4 v[160:163], v243, s[36:39], s47 offen offset:2048
  v_mfma_f32_16x16x32_bf16 v[60:63], v[80:83], v[164:167], v[60:63]
  v_mfma_f32_16x16x32_bf16 v[64:67], v[84:87], v[164:167], v[64:67]
  v_mfma_f32_16x16x32_bf16 v[68:71], v[88:91], v[164:167], v[68:71]
  v_mfma_f32_16x16x32_bf16 v[72:75], v[92:95], v[164:167], v[72:75]
  v_mfma_f32_16x16x32_bf16 v[76:79], v[96:99], v[164:167], v[76:79]
  buffer_load_dwordx4 v[164:167], v244, s[36:39], s47 offen offset:2048
  s_waitcnt lgkmcnt(0)
  s_waitcnt vmcnt(23)
  v_mfma_f32_16x16x32_bf16 v[0:3], v[100:103], v[168:171], v[0:3]
  ds_read_b64_tr_b16 v[80:81], v245 offset:0
  v_mfma_f32_16x16x32_bf16 v[4:7], v[104:107], v[168:171], v[4:7]
  ds_read_b64_tr_b16 v[82:83], v245 offset:2560
  v_mfma_f32_16x16x32_bf16 v[8:11], v[108:111], v[168:171], v[8:11]
  ds_read_b64_tr_b16 v[84:85], v245 offset:32
  v_mfma_f32_16x16x32_bf16 v[12:15], v[112:115], v[168:171], v[12:15]
  ds_read_b64_tr_b16 v[86:87], v245 offset:2592
  v_mfma_f32_16x16x32_bf16 v[16:19], v[116:119], v[168:171], v[16:19]
  ds_read_b64_tr_b16 v[88:89], v245 offset:64
  buffer_load_dwordx4 v[168:171], v241, s[36:39], s47 offen offset:3072
  v_mfma_f32_16x16x32_bf16 v[20:23], v[100:103], v[172:175], v[20:23]
  ds_read_b64_tr_b16 v[90:91], v245 offset:2624
  v_mfma_f32_16x16x32_bf16 v[24:27], v[104:107], v[172:175], v[24:27]
  ds_read_b64_tr_b16 v[92:93], v245 offset:96
  v_mfma_f32_16x16x32_bf16 v[28:31], v[108:111], v[172:175], v[28:31]
  ds_read_b64_tr_b16 v[94:95], v245 offset:2656
  v_mfma_f32_16x16x32_bf16 v[32:35], v[112:115], v[172:175], v[32:35]
  ds_read_b64_tr_b16 v[96:97], v245 offset:128
  v_mfma_f32_16x16x32_bf16 v[36:39], v[116:119], v[172:175], v[36:39]
  ds_read_b64_tr_b16 v[98:99], v245 offset:2688
  buffer_load_dwordx4 v[172:175], v242, s[36:39], s47 offen offset:3072
  v_mfma_f32_16x16x32_bf16 v[40:43], v[100:103], v[176:179], v[40:43]
  s_add_u32 m0, s48, 15360
  s_nop 0
  buffer_load_dwordx4 v236, s[36:39], s44 offen lds
  v_mfma_f32_16x16x32_bf16 v[44:47], v[104:107], v[176:179], v[44:47]
  s_add_u32 m0, s48, 16384
  s_nop 0
  buffer_load_dwordx4 v237, s[36:39], s44 offen lds
  v_mfma_f32_16x16x32_bf16 v[48:51], v[108:111], v[176:179], v[48:51]
  s_add_u32 m0, s48, 17408
  s_nop 0
  buffer_load_dwordx4 v238, s[36:39], s44 offen lds
  v_mfma_f32_16x16x32_bf16 v[52:55], v[112:115], v[176:179], v[52:55]
  s_add_u32 m0, s48, 18432
  s_nop 0
  buffer_load_dwordx4 v239, s[36:39], s44 offen lds
  v_mfma_f32_16x16x32_bf16 v[56:59], v[116:119], v[176:179], v[56:59]
  s_add_u32 m0, s48, 19456
  s_nop 0
  buffer_load_dwordx4 v240, s[36:39], s44 offen lds
  s_add_u32 s44, s44, 40960
  buffer_load_dwordx4 v[176:179], v243, s[36:39], s47 offen offset:3072
  v_mfma_f32_16x16x32_bf16 v[60:63], v[100:103], v[180:183], v[60:63]
  v_mfma_f32_16x16x32_bf16 v[64:67], v[104:107], v[180:183], v[64:67]
  v_mfma_f32_16x16x32_bf16 v[68:71], v[108:111], v[180:183], v[68:71]
  v_mfma_f32_16x16x32_bf16 v[72:75], v[112:115], v[180:183], v[72:75]
  v_mfma_f32_16x16x32_bf16 v[76:79], v[116:119], v[180:183], v[76:79]
  buffer_load_dwordx4 v[180:183], v244, s[36:39], s47 offen offset:3072
  s_waitcnt lgkmcnt(0)
  s_waitcnt vmcnt(20)
  v_mfma_f32_16x16x32_bf16 v[0:3], v[80:83], v[120:123], v[0:3]
  ds_read_b64_tr_b16 v[100:101], v245 offset:5120
  v_mfma_f32_16x16x32_bf16 v[4:7], v[84:87], v[120:123], v[4:7]
  ds_read_b64_tr_b16 v[102:103], v245 offset:7680
  v_mfma_f32_16x16x32_bf16 v[8:11], v[88:91], v[120:123], v[8:11]
  ds_read_b64_tr_b16 v[104:105], v245 offset:5152
  v_mfma_f32_16x16x32_bf16 v[12:15], v[92:95], v[120:123], v[12:15]
  ds_read_b64_tr_b16 v[106:107], v245 offset:7712
  v_mfma_f32_16x16x32_bf16 v[16:19], v[96:99], v[120:123], v[16:19]
  ds_read_b64_tr_b16 v[108:109], v245 offset:5184
  v_mfma_f32_16x16x32_bf16 v[20:23], v[80:83], v[124:127], v[20:23]
  ds_read_b64_tr_b16 v[110:111], v245 offset:7744
  v_mfma_f32_16x16x32_bf16 v[24:27], v[84:87], v[124:127], v[24:27]
  ds_read_b64_tr_b16 v[112:113], v245 offset:5216
  v_mfma_f32_16x16x32_bf16 v[28:31], v[88:91], v[124:127], v[28:31]
  ds_read_b64_tr_b16 v[114:115], v245 offset:7776
  v_mfma_f32_16x16x32_bf16 v[32:35], v[92:95], v[124:127], v[32:35]
  ds_read_b64_tr_b16 v[116:117], v245 offset:5248
  v_mfma_f32_16x16x32_bf16 v[36:39], v[96:99], v[124:127], v[36:39]
  ds_read_b64_tr_b16 v[118:119], v245 offset:7808
  v_mfma_f32_16x16x32_bf16 v[40:43], v[80:83], v[128:131], v[40:43]
  v_mfma_f32_16x16x32_bf16 v[44:47], v[84:87], v[128:131], v[44:47]
  v_mfma_f32_16x16x32_bf16 v[48:51], v[88:91], v[128:131], v[48:51]
  v_mfma_f32_16x16x32_bf16 v[52:55], v[92:95], v[128:131], v[52:55]
  v_mfma_f32_16x16x32_bf16 v[56:59], v[96:99], v[128:131], v[56:59]
  v_mfma_f32_16x16x32_bf16 v[60:63], v[80:83], v[132:135], v[60:63]
  v_mfma_f32_16x16x32_bf16 v[64:67], v[84:87], v[132:135], v[64:67]
  v_mfma_f32_16x16x32_bf16 v[68:71], v[88:91], v[132:135], v[68:71]
  v_mfma_f32_16x16x32_bf16 v[72:75], v[92:95], v[132:135], v[72:75]
  v_mfma_f32_16x16x32_bf16 v[76:79], v[96:99], v[132:135], v[76:79]
  s_waitcnt lgkmcnt(0)
  s_waitcnt vmcnt(11)
  v_mfma_f32_16x16x32_bf16 v[0:3], v[100:103], v[136:139], v[0:3]
  ds_read_b64_tr_b16 v[80:81], v245 offset:10240
  v_mfma_f32_16x16x32_bf16 v[4:7], v[104:107], v[136:139], v[4:7]
  ds_read_b64_tr_b16 v[82:83], v245 offset:12800
  v_mfma_f32_16x16x32_bf16 v[8:11], v[108:111], v[136:139], v[8:11]
  ds_read_b64_tr_b16 v[84:85], v245 offset:10272
  v_mfma_f32_16x16x32_bf16 v[12:15], v[112:115], v[136:139], v[12:15]
  ds_read_b64_tr_b16 v[86:87], v245 offset:12832
  v_mfma_f32_16x16x32_bf16 v[16:19], v[116:119], v[136:139], v[16:19]
  ds_read_b64_tr_b16 v[88:89], v245 offset:10304
  v_mfma_f32_16x16x32_bf16 v[20:23], v[100:103], v[140:143], v[20:23]
  ds_read_b64_tr_b16 v[90:91], v245 offset:12864
  v_mfma_f32_16x16x32_bf16 v[24:27], v[104:107], v[140:143], v[24:27]
  ds_read_b64_tr_b16 v[92:93], v245 offset:10336
  v_mfma_f32_16x16x32_bf16 v[28:31], v[108:111], v[140:143], v[28:31]
  ds_read_b64_tr_b16 v[94:95], v245 offset:12896
  v_mfma_f32_16x16x32_bf16 v[32:35], v[112:115], v[140:143], v[32:35]
  ds_read_b64_tr_b16 v[96:97], v245 offset:10368
  v_mfma_f32_16x16x32_bf16 v[36:39], v[116:119], v[140:143], v[36:39]
  ds_read_b64_tr_b16 v[98:99], v245 offset:12928
  v_mfma_f32_16x16x32_bf16 v[40:43], v[100:103], v[144:147], v[40:43]
  v_mfma_f32_16x16x32_bf16 v[44:47], v[104:107], v[144:147], v[44:47]
  v_mfma_f32_16x16x32_bf16 v[48:51], v[108:111], v[144:147], v[48:51]
  v_mfma_f32_16x16x32_bf16 v[52:55], v[112:115], v[144:147], v[52:55]
  v_mfma_f32_16x16x32_bf16 v[56:59], v[116:119], v[144:147], v[56:59]
  v_mfma_f32_16x16x32_bf16 v[60:63], v[100:103], v[148:151], v[60:63]
  v_mfma_f32_16x16x32_bf16 v[64:67], v[104:107], v[148:151], v[64:67]
  v_mfma_f32_16x16x32_bf16 v[68:71], v[108:111], v[148:151], v[68:71]
  v_mfma_f32_16x16x32_bf16 v[72:75], v[112:115], v[148:151], v[72:75]
  v_mfma_f32_16x16x32_bf16 v[76:79], v[116:119], v[148:151], v[76:79]
  s_waitcnt lgkmcnt(0)
  s_waitcnt vmcnt(2)
  v_mfma_f32_16x16x32_bf16 v[0:3], v[80:83], v[152:155], v[0:3]
  ds_read_b64_tr_b16 v[100:101], v245 offset:15360
  v_mfma_f32_16x16x32_bf16 v[4:7], v[84:87], v[152:155], v[4:7]
  ds_read_b64_tr_b16 v[102:103], v245 offset:17920
  v_mfma_f32_16x16x32_bf16 v[8:11], v[88:91], v[152:155], v[8:11]
  ds_read_b64_tr_b16 v[104:105], v245 offset:15392
  v_mfma_f32_16x16x32_bf16 v[12:15], v[92:95], v[152:155], v[12:15]
  ds_read_b64_tr_b16 v[106:107], v245 offset:17952
  v_mfma_f32_16x16x32_bf16 v[16:19], v[96:99], v[152:155], v[16:19]
  ds_read_b64_tr_b16 v[108:109], v245 offset:15424
  v_mfma_f32_16x16x32_bf16 v[20:23], v[80:83], v[156:159], v[20:23]
  ds_read_b64_tr_b16 v[110:111], v245 offset:17984
  v_mfma_f32_16x16x32_bf16 v[24:27], v[84:87], v[156:159], v[24:27]
  ds_read_b64_tr_b16 v[112:113], v245 offset:15456
  v_mfma_f32_16x16x32_bf16 v[28:31], v[88:91], v[156:159], v[28:31]
  ds_read_b64_tr_b16 v[114:115], v245 offset:18016
  v_mfma_f32_16x16x32_bf16 v[32:35], v[92:95], v[156:159], v[32:35]
  ds_read_b64_tr_b16 v[116:117], v245 offset:15488
  v_mfma_f32_16x16x32_bf16 v[36:39], v[96:99], v[156:159], v[36:39]
  ds_read_b64_tr_b16 v[118:119], v245 offset:18048
  v_mfma_f32_16x16x32_bf16 v[40:43], v[80:83], v[160:163], v[40:43]
  v_mfma_f32_16x16x32_bf16 v[44:47], v[84:87], v[160:163], v[44:47]
  v_mfma_f32_16x16x32_bf16 v[48:51], v[88:91], v[160:163], v[48:51]
  v_mfma_f32_16x16x32_bf16 v[52:55], v[92:95], v[160:163], v[52:55]
  v_mfma_f32_16x16x32_bf16 v[56:59], v[96:99], v[160:163], v[56:59]
  v_mfma_f32_16x16x32_bf16 v[60:63], v[80:83], v[164:167], v[60:63]
  v_mfma_f32_16x16x32_bf16 v[64:67], v[84:87], v[164:167], v[64:67]
  v_mfma_f32_16x16x32_bf16 v[68:71], v[88:91], v[164:167], v[68:71]
  v_mfma_f32_16x16x32_bf16 v[72:75], v[92:95], v[164:167], v[72:75]
  v_mfma_f32_16x16x32_bf16 v[76:79], v[96:99], v[164:167], v[76:79]
  s_waitcnt lgkmcnt(0)
  s_waitcnt vmcnt(0)
  v_mfma_f32_16x16x32_bf16 v[20:23], v[100:103], v[172:175], v[20:23]
  v_mfma_f32_16x16x32_bf16 v[24:27], v[104:107], v[172:175], v[24:27]
  v_mfma_f32_16x16x32_bf16 v[28:31], v[108:111], v[172:175], v[28:31]
  v_mfma_f32_16x16x32_bf16 v[32:35], v[112:115], v[172:175], v[32:35]
  v_mfma_f32_16x16x32_bf16 v[36:39], v[116:119], v[172:175], v[36:39]
  v_mfma_f32_16x16x32_bf16 v[40:43], v[100:103], v[176:179], v[40:43]
  ds_write_b128 v246, v[20:23] offset:0
  v_mfma_f32_16x16x32_bf16 v[44:47], v[104:107], v[176:179], v[44:47]
  ds_write_b128 v246, v[24:27] offset:1024
  v_mfma_f32_16x16x32_bf16 v[48:51], v[108:111], v[176:179], v[48:51]
  ds_write_b128 v246, v[28:31] offset:2048
  v_mfma_f32_16x16x32_bf16 v[52:55], v[112:115], v[176:179], v[52:55]
  ds_write_b128 v246, v[32:35] offset:3072
  v_mfma_f32_16x16x32_bf16 v[56:59], v[116:119], v[176:179], v[56:59]
  ds_write_b128 v246, v[36:39] offset:4096
  v_mfma_f32_16x16x32_bf16 v[60:63], v[100:103], v[180:183], v[60:63]
  ds_write_b128 v246, v[40:43] offset:5120
  v_mfma_f32_16x16x32_bf16 v[64:67], v[104:107], v[180:183], v[64:67]
  ds_write_b128 v246, v[44:47] offset:6144
  v_mfma_f32_16x16x32_bf16 v[68:71], v[108:111], v[180:183], v[68:71]
  ds_write_b128 v246, v[48:51] offset:7168
  v_mfma_f32_16x16x32_bf16 v[72:75], v[112:115], v[180:183], v[72:75]
  ds_write_b128 v246, v[52:55] offset:8192
  v_mfma_f32_16x16x32_bf16 v[76:79], v[116:119], v[180:183], v[76:79]
  ds_write_b128 v246, v[56:59] offset:9216
  v_mfma_f32_16x16x32_bf16 v[0:3], v[100:103], v[168:171], v[0:3]
  ds_write_b128 v246, v[60:63] offset:10240
  v_mfma_f32_16x16x32_bf16 v[4:7], v[104:107], v[168:171], v[4:7]
  ds_write_b128 v246, v[64:67] offset:11264
  v_mfma_f32_16x16x32_bf16 v[8:11], v[108:111], v[168:171], v[8:11]
  ds_write_b128 v246, v[68:71] offset:12288
  v_mfma_f32_16x16x32_bf16 v[12:15], v[112:115], v[168:171], v[12:15]
  ds_write_b128 v246, v[72:75] offset:13312
  v_mfma_f32_16x16x32_bf16 v[16:19], v[116:119], v[168:171], v[16:19]
  ds_write_b128 v246, v[76:79] offset:14336
  s_waitcnt lgkmcnt(0)
  s_barrier
  ds_read_b64_tr_b16 v[204:205], v203 offset:0
  ds_read_b64_tr_b16 v[206:207], v203 offset:2048
  ds_read_b64_tr_b16 v[208:209], v203 offset:4096
  ds_read_b64_tr_b16 v[210:211], v203 offset:6144
  ds_read_b64_tr_b16 v[212:213], v203 offset:8192
  ds_read_b128 v[120:123], v200 offset:0
  ds_read_b128 v[124:127], v201 offset:5120
  ds_read_b128 v[128:131], v202 offset:10240
  ds_read_b128 v[132:135], v200 offset:1024
  ds_read_b128 v[136:139], v201 offset:6144
  ds_read_b128 v[140:143], v202 offset:11264
  ds_read_b128 v[144:147], v200 offset:2048
  ds_read_b128 v[148:151], v201 offset:7168
  ds_read_b128 v[152:155], v202 offset:12288
  ds_read_b128 v[156:159], v200 offset:3072
  ds_read_b128 v[160:163], v201 offset:8192
  ds_read_b128 v[164:167], v202 offset:13312
  ds_read_b128 v[168:171], v200 offset:4096
  ds_read_b128 v[172:175], v201 offset:9216
  ds_read_b128 v[176:179], v202 offset:14336
  s_waitcnt lgkmcnt(15)
  v_lshlrev_b32 v216, 16, v204
  v_and_b32 v217, 0xffff0000, v204
  v_lshlrev_b32 v218, 16, v205
  v_and_b32 v219, 0xffff0000, v205
  v_lshlrev_b32 v220, 16, v206
  v_and_b32 v221, 0xffff0000, v206
  v_lshlrev_b32 v222, 16, v207
  v_and_b32 v223, 0xffff0000, v207
  v_lshlrev_b32 v224, 16, v208
  v_and_b32 v225, 0xffff0000, v208
  v_lshlrev_b32 v226, 16, v209
  v_and_b32 v227, 0xffff0000, v209
  v_lshlrev_b32 v228, 16, v210
  v_and_b32 v229, 0xffff0000, v210
  v_lshlrev_b32 v230, 16, v211
  v_and_b32 v231, 0xffff0000, v211
  v_lshlrev_b32 v232, 16, v212
  v_and_b32 v233, 0xffff0000, v212
  v_lshlrev_b32 v234, 16, v213
  v_and_b32 v235, 0xffff0000, v213
  s_waitcnt lgkmcnt(12)
  v_pk_add_f32 v[120:121], v[120:121], v[0:1]
  v_pk_add_f32 v[124:125], v[124:125], v[128:129]
  v_pk_add_f32 v[122:123], v[122:123], v[2:3]
  v_pk_add_f32 v[126:127], v[126:127], v[130:131]
  v_pk_add_f32 v[120:121], v[120:121], v[124:125]
  v_pk_add_f32 v[122:123], v[122:123], v[126:127]
  v_cvt_pk_bf16_f32 v124, v120, v121
  v_cvt_pk_bf16_f32 v125, v122, v123
  v_lshlrev_b32 v120, 16, v124
  v_and_b32 v121, 0xffff0000, v124
  v_lshlrev_b32 v122, 16, v125
  v_and_b32 v123, 0xffff0000, v125
  v_pk_add_f32 v[120:121], v[120:121], v[216:217]
  v_pk_add_f32 v[122:123], v[122:123], v[218:219]
  v_cvt_pk_bf16_f32 v124, v120, v121
  v_cvt_pk_bf16_f32 v125, v122, v123
  ds_write_b64 v190, v[124:125] offset:0
  s_waitcnt lgkmcnt(10)
  v_pk_add_f32 v[132:133], v[132:133], v[4:5]
  v_pk_add_f32 v[136:137], v[136:137], v[140:141]
  v_pk_add_f32 v[134:135], v[134:135], v[6:7]
  v_pk_add_f32 v[138:139], v[138:139], v[142:143]
  v_pk_add_f32 v[132:133], v[132:133], v[136:137]
  v_pk_add_f32 v[134:135], v[134:135], v[138:139]
  v_cvt_pk_bf16_f32 v136, v132, v133
  v_cvt_pk_bf16_f32 v137, v134, v135
  v_lshlrev_b32 v132, 16, v136
  v_and_b32 v133, 0xffff0000, v136
  v_lshlrev_b32 v134, 16, v137
  v_and_b32 v135, 0xffff0000, v137
  v_pk_add_f32 v[132:133], v[132:133], v[220:221]
  v_pk_add_f32 v[134:135], v[134:135], v[222:223]
  v_cvt_pk_bf16_f32 v136, v132, v133
  v_cvt_pk_bf16_f32 v137, v134, v135
  ds_write_b64 v190, v[136:137] offset:32
  s_waitcnt lgkmcnt(8)
  v_pk_add_f32 v[144:145], v[144:145], v[8:9]
  v_pk_add_f32 v[148:149], v[148:149], v[152:153]
  v_pk_add_f32 v[146:147], v[146:147], v[10:11]
  v_pk_add_f32 v[150:151], v[150:151], v[154:155]
  v_pk_add_f32 v[144:145], v[144:145], v[148:149]
  v_pk_add_f32 v[146:147], v[146:147], v[150:151]
  v_cvt_pk_bf16_f32 v148, v144, v145
  v_cvt_pk_bf16_f32 v149, v146, v147
  v_lshlrev_b32 v144, 16, v148
  v_and_b32 v145, 0xffff0000, v148
  v_lshlrev_b32 v146, 16, v149
  v_and_b32 v147, 0xffff0000, v149
  v_pk_add_f32 v[144:145], v[144:145], v[224:225]
  v_pk_add_f32 v[146:147], v[146:147], v[226:227]
  v_cvt_pk_bf16_f32 v148, v144, v145
  v_cvt_pk_bf16_f32 v149, v146, v147
  ds_write_b64 v190, v[148:149] offset:64
  s_waitcnt lgkmcnt(6)
  v_pk_add_f32 v[156:157], v[156:157], v[12:13]
  v_pk_add_f32 v[160:161], v[160:161], v[164:165]
  v_pk_add_f32 v[158:159], v[158:159], v[14:15]
  v_pk_add_f32 v[162:163], v[162:163], v[166:167]
  v_pk_add_f32 v[156:157], v[156:157], v[160:161]
  v_pk_add_f32 v[158:159], v[158:159], v[162:163]
  v_cvt_pk_bf16_f32 v160, v156, v157
  v_cvt_pk_bf16_f32 v161, v158, v159
  v_lshlrev_b32 v156, 16, v160
  v_and_b32 v157, 0xffff0000, v160
  v_lshlrev_b32 v158, 16, v161
  v_and_b32 v159, 0xffff0000, v161
  v_pk_add_f32 v[156:157], v[156:157], v[228:229]
  v_pk_add_f32 v[158:159], v[158:159], v[230:231]
  v_cvt_pk_bf16_f32 v160, v156, v157
  v_cvt_pk_bf16_f32 v161, v158, v159
  ds_write_b64 v190, v[160:161] offset:96
  s_waitcnt lgkmcnt(4)
  v_pk_add_f32 v[168:169], v[168:169], v[16:17]
  v_pk_add_f32 v[172:173], v[172:173], v[176:177]
  v_pk_add_f32 v[170:171], v[170:171], v[18:19]
  v_pk_add_f32 v[174:175], v[174:175], v[178:179]
  v_pk_add_f32 v[168:169], v[168:169], v[172:173]
  v_pk_add_f32 v[170:171], v[170:171], v[174:175]
  v_cvt_pk_bf16_f32 v172, v168, v169
  v_cvt_pk_bf16_f32 v173, v170, v171
  v_lshlrev_b32 v168, 16, v172
  v_and_b32 v169, 0xffff0000, v172
  v_lshlrev_b32 v170, 16, v173
  v_and_b32 v171, 0xffff0000, v173
  v_pk_add_f32 v[168:169], v[168:169], v[232:233]
  v_pk_add_f32 v[170:171], v[170:171], v[234:235]
  v_cvt_pk_bf16_f32 v172, v168, v169
  v_cvt_pk_bf16_f32 v173, v170, v171
  ds_write_b64 v190, v[172:173] offset:128
  ds_read_b128 v[80:83], v191 offset:0
  ds_read_b128 v[84:87], v191 offset:1024
  ds_read_b128 v[88:91], v191 offset:2048
  s_waitcnt lgkmcnt(2)
  buffer_store_dwordx4 v[80:83], v192, s[20:23], s50 offen
  s_waitcnt lgkmcnt(1)
  buffer_store_dwordx4 v[84:87], v193, s[20:23], s50 offen
  s_waitcnt lgkmcnt(0)
  s_mov_b32 exec_hi, 0
  buffer_store_dwordx4 v[88:91], v194, s[20:23], s50 offen
gemm2_kernel_end:
  s_endpgm
.section .rodata,"a"
.p2align 6
.amdhsa_kernel prep_kernel
  .amdhsa_next_free_vgpr 212
  .amdhsa_next_free_sgpr 102
  .amdhsa_accum_offset 212
  .amdhsa_group_segment_fixed_size 0
  .amdhsa_kernarg_size 104
  .amdhsa_user_sgpr_count 2
  .amdhsa_user_sgpr_kernarg_segment_ptr 1
  .amdhsa_system_sgpr_workgroup_id_x 1
.end_amdhsa_kernel
.p2align 6
.amdhsa_kernel conv_kernel
  .amdhsa_next_free_vgpr 164
  .amdhsa_next_free_sgpr 102
  .amdhsa_accum_offset 164
  .amdhsa_group_segment_fixed_size 0
  .amdhsa_kernarg_size 104
  .amdhsa_user_sgpr_count 2
  .amdhsa_user_sgpr_kernarg_segment_ptr 1
  .amdhsa_system_sgpr_workgroup_id_x 1
.end_amdhsa_kernel
.p2align 6
.amdhsa_kernel gemm1_kernel
  .amdhsa_next_free_vgpr 224
  .amdhsa_next_free_sgpr 102
  .amdhsa_accum_offset 224
  .amdhsa_group_segment_fixed_size 0
  .amdhsa_kernarg_size 104
  .amdhsa_user_sgpr_count 2
  .amdhsa_user_sgpr_kernarg_segment_ptr 1
  .amdhsa_system_sgpr_workgroup_id_x 1
.end_amdhsa_kernel
.p2align 6
.amdhsa_kernel gemm2_kernel
  .amdhsa_next_free_vgpr 252
  .amdhsa_next_free_sgpr 102
  .amdhsa_accum_offset 252
  .amdhsa_group_segment_fixed_size 0
  .amdhsa_kernarg_size 104
  .amdhsa_user_sgpr_count 2
  .amdhsa_user_sgpr_kernarg_segment_ptr 1
  .amdhsa_system_sgpr_workgroup_id_x 1
.end_amdhsa_kernel
```
